```python
import torch

def _softmax(x, axis=-1):
    return torch.softmax(x, dim=axis)

def _gelu(x):
    return torch.nn.functional.gelu(x, approximate='tanh')

def _silu(x):
    return torch.nn.functional.silu(x)

def _sigmoid(x):
    return torch.sigmoid(x)

def _layernorm(x, axis=-1, eps=1e-05):
    m = x.mean(dim=axis, keepdim=True)
    v = x.var(dim=axis, keepdim=True, unbiased=False)
    return (x - m) / torch.sqrt(v + eps)

def _scatter_add(tgt, idx, src, axis=0):
    return tgt.clone().index_add_(axis, idx, src)

def _segment_sum(src, seg, n):
    out = torch.zeros((n,) + src.shape[1:], dtype=src.dtype)
    return out.index_add_(0, seg, src)

def _pad(x, pw):
    flat = tuple((v for pair in reversed(pw) for v in pair))
    return torch.nn.functional.pad(x, flat)
kernel_name = 'adaLN_cond__softmax_full_mha__glu_gated_geglu__prompt'

def setup_inputs():

    _w = lambda a: (lambda t: t.to(torch.bfloat16) if t.is_floating_point() else t)(torch.as_tensor(a))

    def _A_setup():
        B, S, D = (1, 2048, 512)
        return {'x': _w((lambda *s: torch.randn(*s, dtype=torch.bfloat16) * 0.05)(B, S, D)), 'wqkv': _w((lambda *s: torch.randn(*s, dtype=torch.bfloat16) * 0.05)(D, 3 * D)), 'wo': _w((lambda *s: torch.randn(*s, dtype=torch.bfloat16) * 0.05)(D, D))}
    _A_in = _A_setup()

    def _B_setup():
        B, S, Dm, Df = (1, 2048, 512, 1792)
        return {'x': _w((lambda *s: torch.randn(*s, dtype=torch.bfloat16) * 0.05)(B, S, Dm)), 'w_gate': _w((lambda *s: torch.randn(*s, dtype=torch.bfloat16) * 0.8)(Dm, Df) * Dm ** (-0.5)), 'w_up': _w((lambda *s: torch.randn(*s, dtype=torch.bfloat16) * 0.8)(Dm, Df) * Dm ** (-0.5)), 'w_down': _w((lambda *s: torch.randn(*s, dtype=torch.bfloat16) * 0.8)(Df, Dm) * Df ** (-0.5))}
    _B_in = _B_setup()
    return {'A_x': _A_in['x'], 'A_wqkv': _A_in['wqkv'], 'A_wo': _A_in['wo'], 'B_x': _B_in['x'], 'B_w_gate': _B_in['w_gate'], 'B_w_up': _B_in['w_up'], 'B_w_down': _B_in['w_down'], 'c': _w((lambda *s: torch.randn(*s, dtype=torch.bfloat16) * 0.1)(1, 512) * 8.0), 'w_mod': _w((lambda *s: torch.randn(*s, dtype=torch.bfloat16) * 0.1)(512, 6 * 512) * 512 ** (-0.5) * 8.0)}

def reference(A_x, A_wqkv, A_wo, B_x, B_w_gate, B_w_up, B_w_down, c, w_mod):

    def _A_ref(x, wqkv, wo):
        B, S, D = x.shape
        H = 32
        Dh = D // H
        qkv = (lambda x, *d: x.permute(*d))((x @ wqkv).reshape(B, S, 3, H, Dh), 2, 0, 3, 1, 4)
        q, k, v = (qkv[0], qkv[1], qkv[2])
        scale = Dh ** (-0.5)
        scores = torch.einsum('bhqd,bhkd->bhqk', q, k) * scale
        p = _softmax(scores, axis=-1)
        o = torch.einsum('bhqk,bhkd->bhqd', p, v)
        return (lambda x, *d: x.permute(*d))(o, 0, 2, 1, 3).reshape(B, S, D) @ wo

    def _B_ref(x, w_gate, w_up, w_down):
        g = torch.einsum('bsd,df->bsf', x, w_gate)
        u = torch.einsum('bsd,df->bsf', x, w_up)
        h = _gelu(g) * u
        return torch.einsum('bsf,fd->bsd', h, w_down)
    x = A_x
    mod = (_silu(c) @ w_mod).reshape(c.shape[0], 6, 1, -1)
    sa, ca, ga, sb, cb, gb = (mod[:, 0].clone(), mod[:, 1].clone(), mod[:, 2].clone(), mod[:, 3].clone(), mod[:, 4].clone(), mod[:, 5].clone())
    h = _layernorm(x, axis=-1) * (1 + ca) + sa
    x = x + ga * _A_ref(h, A_wqkv, A_wo)
    h = _layernorm(x, axis=-1) * (1 + cb) + sb
    x = x + gb * _B_ref(h, B_w_gate, B_w_up, B_w_down)
    return x
```

```asm
; @launch grid=(256,1,1) block=(512,1,1) lds=163840
.amdgcn_target "amdgcn-amd-amdhsa--gfx950"
.text
.globl adaLN_cond__softmax_full_mha__glu_gated_geglu__prompt_kernel
.p2align 8
.type adaLN_cond__softmax_full_mha__glu_gated_geglu__prompt_kernel,@function
adaLN_cond__softmax_full_mha__glu_gated_geglu__prompt_kernel:
    s_cmp_ge_u32 s2, 256
    s_cbranch_scc1 L_exit
    s_load_dwordx2 s[32:33], s[0:1], 56
    s_load_dwordx2 s[36:37], s[0:1], 64
    s_load_dwordx2 s[8:9], s[0:1], 0
    s_load_dwordx2 s[44:45], s[0:1], 88
    s_load_dwordx2 s[12:13], s[0:1], 8
    s_getpc_b64 s[4:5]
    v_lshlrev_b32 v6, 7, v0
    v_cmp_gt_u32 vcc, 64, v0
    v_mov_b32 v7, s5
    s_and_saveexec_b64 s[60:61], vcc
    s_cbranch_execz L_ncp_1
    v_add_co_u32 v6, vcc, s4, v6
    s_nop 1
    v_addc_co_u32 v7, vcc, 0, v7, vcc
    global_load_dword v12, v[6:7], off
L_ncp_1:
    s_mov_b64 exec, -1
    v_lshrrev_b32 v2, 6, v0
    v_and_b32 v1, 63, v0
    v_readfirstlane_b32 s50, v2
    s_and_b32 s48, s2, 7
    s_lshr_b32 s49, s2, 3
    s_mov_b32 s34, 1024
    s_mov_b32 s35, 0x20000
    s_mov_b32 s38, 3145728
    s_mov_b32 s39, 0x20000
    s_mov_b32 s10, 2097152
    s_mov_b32 s11, 0x20000
    v_lshlrev_b32 v4, 4, v1
    v_lshrrev_b32 v2, 2, v0
    v_lshlrev_b32 v6, 1, v2
    v_mul_u32_u24 v2, 6144, v2
    v_and_b32 v3, 3, v0
    v_lshl_add_u32 v7, v3, 3, v2
    s_lshr_b32 s4, s2, 6
    s_lshl_b32 s3, s4, 8
    s_mul_i32 s4, s4, 786432
    s_lshl_b32 s5, s48, 8
    s_add_u32 s4, s4, s5
    s_and_b32 s5, s2, 0x38
    s_lshl_b32 s5, s5, 2
    s_add_u32 s4, s4, s5
    s_lshl_b32 s96, s49, 3
    s_add_u32 s96, s96, s50
    s_lshl_b32 s96, s96, 13
    s_add_u32 s97, s96, 4096
    s_waitcnt lgkmcnt(0)
    buffer_load_ushort v16, v6, s[32:35], s3 offen
    buffer_load_dwordx2 v[18:19], v7, s[36:39], s4 offen
    s_barrier
    buffer_load_dwordx4 v[32:35], v4, s[8:11], s96 offen offset:0
    buffer_load_dwordx4 v[36:39], v4, s[8:11], s96 offen offset:1024
    buffer_load_dwordx4 v[40:43], v4, s[8:11], s96 offen offset:2048
    s_load_dword s51, s[44:45], 0
    s_load_dwordx2 s[16:17], s[0:1], 16
    s_load_dwordx2 s[20:21], s[0:1], 32
    s_load_dwordx2 s[24:25], s[0:1], 40
    s_load_dwordx2 s[28:29], s[0:1], 48
    s_load_dwordx2 s[40:41], s[0:1], 72
    s_mov_b32 s14, 1572864
    s_mov_b32 s15, 0x20000
    s_mov_b32 s46, 11534336
    s_mov_b32 s47, 0x20000
    s_getpc_b64 s[4:5]
L_pc:
    v_lshrrev_b32 v6, 5, v0
    v_and_b32 v6, 14, v6
    v_and_b32 v7, 1, v0
    v_add_u32 v6, v6, v7
    s_lshl_b32 s3, s49, 4
    v_add_u32 v6, s3, v6
    v_lshlrev_b32 v6, 7, v6
    v_min_u32 v6, L_codeend-L_pc-4, v6
    v_mov_b32 v7, s5
    v_add_co_u32 v6, vcc, s4, v6
    s_nop 1
    v_addc_co_u32 v7, vcc, 0, v7, vcc
    s_mov_b64 exec, 3
    global_load_dword v15, v[6:7], off
    s_mov_b64 exec, -1
    s_cmp_lg_u32 s50, 1
    s_cbranch_scc1 L_pre_2
    s_mul_i32 s3, s49, 1536
    v_min_u32 v2, 11, v1
    v_lshlrev_b32 v2, 7, v2
    buffer_load_dword v14, v2, s[44:47], s3 offen
L_pre_2:
    s_lshl_b32 s55, s50, 10
    v_bfe_u32 v2, v1, 4, 1
    v_lshlrev_b32 v2, 2, v2
    v_and_b32 v3, 7, v1
    v_xor_b32 v2, v2, v3
    v_lshlrev_b32 v2, 4, v2
    v_lshrrev_b32 v3, 3, v0
    v_mul_u32_u24 v3, 3072, v3
    s_lshl_b32 s3, s48, 7
    v_add3_u32 v5, v2, v3, s3
    s_and_b32 s98, s49, 7
    s_add_u32 s6, s98, 0
    s_and_b32 s6, s6, 7
    s_mul_i32 s6, s6, 196608
    s_add_u32 m0, s55, 67584
    s_nop 0
    buffer_load_dwordx4 v5, s[12:15], s6 offen lds
    s_add_u32 s6, s98, 0
    s_and_b32 s6, s6, 7
    s_mul_i32 s6, s6, 196608
    s_add_u32 m0, s55, 75776
    s_add_u32 s6, s6, 1024
    buffer_load_dwordx4 v5, s[12:15], s6 offen lds
    s_add_u32 s6, s98, 0
    s_and_b32 s6, s6, 7
    s_mul_i32 s6, s6, 196608
    s_add_u32 m0, s55, 83968
    s_add_u32 s6, s6, 2048
    buffer_load_dwordx4 v5, s[12:15], s6 offen lds
    s_getreg_b32 s54, hwreg(HW_REG_XCC_ID, 0, 4)
    s_mov_b32 s18, 524288
    s_mov_b32 s19, 0x20000
    s_mov_b32 s22, 1835008
    s_mov_b32 s23, 0x20000
    s_mov_b32 s26, 1835008
    s_mov_b32 s27, 0x20000
    s_mov_b32 s30, 1835008
    s_mov_b32 s31, 0x20000
    s_mov_b32 s42, 2097152
    s_mov_b32 s43, 0x20000
    s_and_b32 s58, s49, 15
    s_and_b32 s57, s49, 7
    s_lshr_b32 s3, s49, 3
    s_lshl_b32 s3, s3, 6
    s_lshl_b32 s56, s48, 8
    s_add_u32 s56, s56, s3
    s_mov_b32 s99, 0x3f803f80
    v_lshrrev_b32 v6, 5, v1
    v_lshlrev_b32 v6, 3, v6
    v_bfe_u32 v7, v1, 2, 2
    v_add_u32 v6, v6, v7
    v_lshlrev_b32 v6, 7, v6
    v_bfe_u32 v7, v1, 3, 1
    v_lshl_add_u32 v6, v7, 6, v6
    v_bfe_u32 v7, v1, 4, 1
    v_lshl_add_u32 v6, v7, 5, v6
    v_and_b32 v7, 3, v1
    v_lshl_add_u32 v6, v7, 3, v6
    s_sub_u32 s3, s50, 4
    s_lshr_b32 s3, s3, 1
    s_add_u32 s3, s3, 4
    s_cmp_lt_u32 s50, 4
    s_cselect_b32 s3, s50, s3
    s_and_b32 s4, s3, 1
    s_lshl_b32 s4, s4, 6
    v_xor_b32 v6, s4, v6
    s_lshr_b32 s3, s3, 1
    s_lshl_b32 s3, s3, 13
    s_add_u32 s3, s3, 67584
    v_add_u32 v6, s3, v6
    v_add_u32 v7, 73728, v6
    s_lshl_b32 s3, s98, 3
    v_subrev_u32 v2, s3, v1
    v_and_b32 v2, 63, v2
    v_mul_u32_u24 v2, 528, v2
    s_lshr_b32 s3, s50, 2
    s_mul_i32 s3, s3, 33792
    s_and_b32 s4, s50, 3
    s_lshl_b32 s4, s4, 7
    s_add_u32 s3, s3, s4
    s_add_u32 s3, s3, 0
    v_add_u32 v11, s3, v2
    v_and_b32 v8, 31, v1
    v_lshlrev_b32 v9, 3, v8
    v_lshlrev_b32 v8, 4, v8
    v_lshrrev_b32 v10, 5, v1
    v_lshl_add_u32 v8, v10, 13, v8
    s_lshl_b32 s100, s50, 9
    s_add_u32 s100, s100, 32768
    s_lshl_b32 s101, s48, 8
    s_add_u32 s101, s101, 4096
    v_add_u32 v10, 4096, v8
    s_waitcnt vmcnt(8)
    v_lshlrev_b32 v16, 16, v16
    v_mul_f32 v17, 0xbfb8aa3b, v16
    v_exp_f32 v17, v17
    s_nop 0
    v_add_f32 v17, 1.0, v17
    v_rcp_f32 v17, v17
    s_nop 0
    v_mul_f32 v17, v17, v16
    v_cvt_pk_bf16_f32 v17, v17, v17
    v_lshlrev_b32 v16, 16, v17
    v_mov_b32 v12, v16
    s_waitcnt vmcnt(7)
    v_lshlrev_b32 v20, 16, v18
    v_and_b32 v21, 0xffff0000, v18
    v_lshlrev_b32 v22, 16, v19
    v_and_b32 v23, 0xffff0000, v19
    v_mul_f32 v20, v20, v16
    v_mul_f32 v21, v21, v16
    v_mul_f32 v22, v22, v16
    v_mul_f32 v23, v23, v16
    s_nop 0
    v_permlane32_swap_b32 v20, v22
    v_permlane32_swap_b32 v21, v23
    v_add_f32 v20, v20, v22
    v_add_f32 v21, v21, v23
    s_nop 1
    v_permlane16_swap_b32 v20, v21
    v_add_f32 v20, v20, v21
    s_nop 1
    v_add_f32_dpp v20, v20, v20 row_ror:8 row_mask:0xf bank_mask:0xf
    s_nop 1
    v_add_f32_dpp v20, v20, v20 row_ror:4 row_mask:0xf bank_mask:0xf
    v_and_b32 v2, 3, v1
    v_lshlrev_b32 v2, 4, v2
    v_lshrrev_b32 v3, 4, v1
    v_lshl_add_u32 v2, v3, 2, v2
    s_lshl_b32 s3, s50, 6
    s_add_u32 s3, s3, 147456
    v_add_u32 v2, s3, v2
    ds_write_b32 v2, v20
    s_waitcnt lgkmcnt(0)
    s_mul_i32 s3, s51, 0x9E3779B1
    s_add_u32 s51, s3, 0x7F4A7C15
    s_mul_i32 s52, s51, 0x85EBCA6B
    s_xor_b32 s52, s52, 0x5BD1E995
    s_waitcnt lgkmcnt(0)
    s_barrier
    s_cmp_lg_u32 s50, 0
    s_cbranch_scc1 L_nopub_3
    v_and_b32 v2, 31, v1
    v_lshlrev_b32 v2, 4, v2
    v_add_u32 v2, 147456, v2
    ds_read_b128 v[24:27], v2
    s_lshr_b32 s3, s49, 3
    s_lshl_b32 s3, s3, 12
    s_lshl_b32 s4, s48, 9
    s_add_u32 s3, s3, s4
    s_and_b32 s4, s49, 7
    s_lshl_b32 s4, s4, 6
    s_add_u32 s3, s3, s4
    s_add_u32 s3, s3, 32768
    s_waitcnt lgkmcnt(0)
    v_add_f32_dpp v24, v24, v24 row_ror:8 row_mask:0xf bank_mask:0xf
    v_add_f32_dpp v25, v25, v25 row_ror:8 row_mask:0xf bank_mask:0xf
    v_add_f32_dpp v26, v26, v26 row_ror:8 row_mask:0xf bank_mask:0xf
    v_add_f32_dpp v27, v27, v27 row_ror:8 row_mask:0xf bank_mask:0xf
    v_add_f32_dpp v24, v24, v24 row_ror:4 row_mask:0xf bank_mask:0xf
    v_add_f32_dpp v25, v25, v25 row_ror:4 row_mask:0xf bank_mask:0xf
    v_add_f32_dpp v26, v26, v26 row_ror:4 row_mask:0xf bank_mask:0xf
    v_add_f32_dpp v27, v27, v27 row_ror:4 row_mask:0xf bank_mask:0xf
    v_mov_b32 v28, v24
    v_mov_b32 v29, v25
    v_mov_b32 v30, v26
    v_mov_b32 v31, v27
    v_permlane16_swap_b32 v24, v28
    v_permlane16_swap_b32 v25, v29
    v_permlane16_swap_b32 v26, v30
    v_permlane16_swap_b32 v27, v31
    v_add_f32 v24, v24, v28
    v_add_f32 v25, v25, v29
    v_add_f32 v26, v26, v30
    v_add_f32 v27, v27, v31
    v_add_u32 v24, 0x80, v24
    v_add_u32 v25, 0x80, v25
    v_add_u32 v26, 0x80, v26
    v_add_u32 v27, 0x80, v27
    s_mov_b32 s4, 0xff
    s_lshr_b32 s5, s51, 0
    v_mov_b32 v28, s5
    v_bfi_b32 v24, s4, v28, v24
    s_lshr_b32 s5, s51, 8
    v_mov_b32 v28, s5
    v_bfi_b32 v25, s4, v28, v25
    s_lshr_b32 s5, s51, 16
    v_mov_b32 v28, s5
    v_bfi_b32 v26, s4, v28, v26
    s_lshr_b32 s5, s51, 24
    v_mov_b32 v28, s5
    v_bfi_b32 v27, s4, v28, v27
    s_mov_b64 exec, 15
    buffer_store_dwordx4 v[24:27], v4, s[44:47], s3 offen sc1
    s_add_u32 s4, s52, s54
    v_mov_b32 v28, s51
    v_mov_b32 v29, s4
    s_lshl_b32 s3, s48, 5
    s_add_u32 s3, s3, s49
    s_lshl_b32 s3, s3, 3
    s_add_u32 s3, s3, 4096
    s_mov_b64 exec, 1
    buffer_store_dwordx2 v[28:29], v4, s[44:47], s3 offen sc1
    s_mov_b64 exec, -1
L_nopub_3:
    buffer_load_dwordx4 v[44:47], v4, s[8:11], s96 offen offset:3072
    s_waitcnt vmcnt(7)
    v_dot2_f32_bf16 v16, v32, s99, 0
    v_dot2_f32_bf16 v20, v32, v32, 0
    v_dot2_f32_bf16 v16, v33, s99, v16
    v_dot2_f32_bf16 v20, v33, v33, v20
    v_dot2_f32_bf16 v16, v34, s99, v16
    v_dot2_f32_bf16 v20, v34, v34, v20
    v_dot2_f32_bf16 v16, v35, s99, v16
    v_dot2_f32_bf16 v20, v35, v35, v20
    v_lshlrev_b32 v64, 16, v32
    v_and_b32 v65, 0xffff0000, v32
    v_lshlrev_b32 v66, 16, v33
    v_and_b32 v67, 0xffff0000, v33
    v_lshlrev_b32 v68, 16, v34
    v_and_b32 v69, 0xffff0000, v34
    v_lshlrev_b32 v70, 16, v35
    v_and_b32 v71, 0xffff0000, v35
    s_add_u32 s6, s98, 1
    s_and_b32 s6, s6, 7
    s_mul_i32 s6, s6, 196608
    s_add_u32 m0, s55, 92160
    s_nop 0
    buffer_load_dwordx4 v5, s[12:15], s6 offen lds
    s_add_u32 s6, s98, 1
    s_and_b32 s6, s6, 7
    s_mul_i32 s6, s6, 196608
    s_add_u32 m0, s55, 100352
    s_add_u32 s6, s6, 1024
    buffer_load_dwordx4 v5, s[12:15], s6 offen lds
    s_add_u32 s6, s98, 1
    s_and_b32 s6, s6, 7
    s_mul_i32 s6, s6, 196608
    s_add_u32 m0, s55, 108544
    s_add_u32 s6, s6, 2048
    buffer_load_dwordx4 v5, s[12:15], s6 offen lds
    s_waitcnt vmcnt(9)
    v_dot2_f32_bf16 v17, v36, s99, 0
    v_dot2_f32_bf16 v21, v36, v36, 0
    v_dot2_f32_bf16 v17, v37, s99, v17
    v_dot2_f32_bf16 v21, v37, v37, v21
    v_dot2_f32_bf16 v17, v38, s99, v17
    v_dot2_f32_bf16 v21, v38, v38, v21
    v_dot2_f32_bf16 v17, v39, s99, v17
    v_dot2_f32_bf16 v21, v39, v39, v21
    v_lshlrev_b32 v72, 16, v36
    v_and_b32 v73, 0xffff0000, v36
    v_lshlrev_b32 v74, 16, v37
    v_and_b32 v75, 0xffff0000, v37
    v_lshlrev_b32 v76, 16, v38
    v_and_b32 v77, 0xffff0000, v38
    v_lshlrev_b32 v78, 16, v39
    v_and_b32 v79, 0xffff0000, v39
    buffer_load_dwordx4 v[48:51], v4, s[8:11], s97 offen offset:0
    s_waitcnt vmcnt(9)
    v_dot2_f32_bf16 v18, v40, s99, 0
    v_dot2_f32_bf16 v22, v40, v40, 0
    v_dot2_f32_bf16 v18, v41, s99, v18
    v_dot2_f32_bf16 v22, v41, v41, v22
    v_dot2_f32_bf16 v18, v42, s99, v18
    v_dot2_f32_bf16 v22, v42, v42, v22
    v_dot2_f32_bf16 v18, v43, s99, v18
    v_dot2_f32_bf16 v22, v43, v43, v22
    v_lshlrev_b32 v80, 16, v40
    v_and_b32 v81, 0xffff0000, v40
    v_lshlrev_b32 v82, 16, v41
    v_and_b32 v83, 0xffff0000, v41
    v_lshlrev_b32 v84, 16, v42
    v_and_b32 v85, 0xffff0000, v42
    v_lshlrev_b32 v86, 16, v43
    v_and_b32 v87, 0xffff0000, v43
    s_waitcnt vmcnt(5)
    s_waitcnt lgkmcnt(0)
    s_barrier
    ds_read_b64_tr_b16 v[128:129], v6 offset:0
    ds_read_b64_tr_b16 v[130:131], v6 offset:512
    ds_read_b64_tr_b16 v[132:133], v6 offset:2048
    ds_read_b64_tr_b16 v[134:135], v6 offset:2560
    ds_read_b64_tr_b16 v[136:137], v6 offset:4096
    ds_read_b64_tr_b16 v[138:139], v6 offset:4608
    ds_read_b64_tr_b16 v[140:141], v6 offset:6144
    ds_read_b64_tr_b16 v[142:143], v6 offset:6656
    s_add_u32 s6, s98, 2
    s_and_b32 s6, s6, 7
    s_mul_i32 s6, s6, 196608
    s_add_u32 m0, s55, 116736
    s_nop 0
    buffer_load_dwordx4 v5, s[12:15], s6 offen lds
    s_add_u32 s6, s98, 2
    s_and_b32 s6, s6, 7
    s_mul_i32 s6, s6, 196608
    s_add_u32 m0, s55, 124928
    s_add_u32 s6, s6, 1024
    buffer_load_dwordx4 v5, s[12:15], s6 offen lds
    s_add_u32 s6, s98, 2
    s_and_b32 s6, s6, 7
    s_mul_i32 s6, s6, 196608
    s_add_u32 m0, s55, 133120
    s_add_u32 s6, s6, 2048
    buffer_load_dwordx4 v5, s[12:15], s6 offen lds
    buffer_load_dwordx4 v[52:55], v4, s[8:11], s97 offen offset:1024
    s_waitcnt vmcnt(8)
    v_dot2_f32_bf16 v19, v44, s99, 0
    v_dot2_f32_bf16 v23, v44, v44, 0
    v_dot2_f32_bf16 v19, v45, s99, v19
    v_dot2_f32_bf16 v23, v45, v45, v23
    v_dot2_f32_bf16 v19, v46, s99, v19
    v_dot2_f32_bf16 v23, v46, v46, v23
    v_dot2_f32_bf16 v19, v47, s99, v19
    v_dot2_f32_bf16 v23, v47, v47, v23
    v_lshlrev_b32 v88, 16, v44
    v_and_b32 v89, 0xffff0000, v44
    v_lshlrev_b32 v90, 16, v45
    v_and_b32 v91, 0xffff0000, v45
    v_lshlrev_b32 v92, 16, v46
    v_and_b32 v93, 0xffff0000, v46
    v_lshlrev_b32 v94, 16, v47
    v_and_b32 v95, 0xffff0000, v47
    buffer_load_dwordx4 v[32:35], v8, s[44:47], s100 offen sc1
    buffer_load_dwordx4 v[36:39], v10, s[44:47], s100 offen sc1
    buffer_load_dwordx2 v[40:41], v9, s[44:47], s101 offen sc1
    v_permlane32_swap_b32 v16, v20
    v_permlane32_swap_b32 v17, v21
    v_permlane32_swap_b32 v18, v22
    v_permlane32_swap_b32 v19, v23
    v_add_f32 v16, v16, v20
    v_add_f32 v17, v17, v21
    v_add_f32 v18, v18, v22
    v_add_f32 v19, v19, v23
    s_nop 0
    v_permlane16_swap_b32 v16, v18
    v_permlane16_swap_b32 v17, v19
    v_add_f32 v16, v16, v18
    v_add_f32 v17, v17, v19
    s_nop 0
    v_add_f32_dpp v16, v16, v16 row_ror:8 row_mask:0xf bank_mask:0xf
    v_add_f32_dpp v17, v17, v17 row_ror:8 row_mask:0xf bank_mask:0xf
    s_nop 0
    v_add_f32_dpp v16, v16, v16 row_ror:4 row_mask:0xf bank_mask:0xf
    v_add_f32_dpp v17, v17, v17 row_ror:4 row_mask:0xf bank_mask:0xf
    s_nop 0
    v_add_f32_dpp v16, v16, v16 row_ror:2 row_mask:0xf bank_mask:0xf
    v_add_f32_dpp v17, v17, v17 row_ror:2 row_mask:0xf bank_mask:0xf
    s_nop 0
    v_add_f32_dpp v16, v16, v16 row_ror:1 row_mask:0xf bank_mask:0xf
    v_add_f32_dpp v17, v17, v17 row_ror:1 row_mask:0xf bank_mask:0xf
    s_nop 1
    v_permlane32_swap_b32 v16, v17
    v_mul_f32 v16, 0x3b000000, v16
    v_mul_f32 v17, 0x3b000000, v17
    v_fma_f32 v17, -v16, v16, v17
    v_max_f32 v17, 0, v17
    v_add_f32 v17, 0x3727c5ac, v17
    v_rsq_f32 v17, v17
    s_nop 0
    v_mul_f32_e64 v16, -v16, v17
    v_readlane_b32 s80, v17, 0
    v_readlane_b32 s81, v16, 0
    v_readlane_b32 s84, v17, 16
    v_readlane_b32 s85, v16, 16
    v_readlane_b32 s82, v17, 32
    v_readlane_b32 s83, v16, 32
    v_readlane_b32 s86, v17, 48
    v_readlane_b32 s87, v16, 48
    v_pk_fma_f32 v[64:65], v[64:65], s[80:81], s[80:81] op_sel:[0,0,1] op_sel_hi:[1,0,1]
    v_pk_fma_f32 v[66:67], v[66:67], s[80:81], s[80:81] op_sel:[0,0,1] op_sel_hi:[1,0,1]
    v_pk_fma_f32 v[68:69], v[68:69], s[80:81], s[80:81] op_sel:[0,0,1] op_sel_hi:[1,0,1]
    v_pk_fma_f32 v[70:71], v[70:71], s[80:81], s[80:81] op_sel:[0,0,1] op_sel_hi:[1,0,1]
    v_pk_fma_f32 v[72:73], v[72:73], s[82:83], s[82:83] op_sel:[0,0,1] op_sel_hi:[1,0,1]
    v_pk_fma_f32 v[74:75], v[74:75], s[82:83], s[82:83] op_sel:[0,0,1] op_sel_hi:[1,0,1]
    v_pk_fma_f32 v[76:77], v[76:77], s[82:83], s[82:83] op_sel:[0,0,1] op_sel_hi:[1,0,1]
    v_pk_fma_f32 v[78:79], v[78:79], s[82:83], s[82:83] op_sel:[0,0,1] op_sel_hi:[1,0,1]
    v_pk_fma_f32 v[80:81], v[80:81], s[84:85], s[84:85] op_sel:[0,0,1] op_sel_hi:[1,0,1]
    v_pk_fma_f32 v[82:83], v[82:83], s[84:85], s[84:85] op_sel:[0,0,1] op_sel_hi:[1,0,1]
    v_pk_fma_f32 v[84:85], v[84:85], s[84:85], s[84:85] op_sel:[0,0,1] op_sel_hi:[1,0,1]
    v_pk_fma_f32 v[86:87], v[86:87], s[84:85], s[84:85] op_sel:[0,0,1] op_sel_hi:[1,0,1]
    v_pk_fma_f32 v[88:89], v[88:89], s[86:87], s[86:87] op_sel:[0,0,1] op_sel_hi:[1,0,1]
    v_pk_fma_f32 v[90:91], v[90:91], s[86:87], s[86:87] op_sel:[0,0,1] op_sel_hi:[1,0,1]
    v_pk_fma_f32 v[92:93], v[92:93], s[86:87], s[86:87] op_sel:[0,0,1] op_sel_hi:[1,0,1]
    v_pk_fma_f32 v[94:95], v[94:95], s[86:87], s[86:87] op_sel:[0,0,1] op_sel_hi:[1,0,1]
    s_waitcnt vmcnt(8)
    s_waitcnt lgkmcnt(0)
    s_barrier
    ds_read_b64_tr_b16 v[144:145], v6 offset:24576
    ds_read_b64_tr_b16 v[146:147], v6 offset:25088
    ds_read_b64_tr_b16 v[148:149], v6 offset:26624
    ds_read_b64_tr_b16 v[150:151], v6 offset:27136
    ds_read_b64_tr_b16 v[152:153], v6 offset:28672
    ds_read_b64_tr_b16 v[154:155], v6 offset:29184
    ds_read_b64_tr_b16 v[156:157], v6 offset:30720
    ds_read_b64_tr_b16 v[158:159], v6 offset:31232
    s_add_u32 s6, s98, 3
    s_and_b32 s6, s6, 7
    s_mul_i32 s6, s6, 196608
    s_add_u32 m0, s55, 67584
    s_nop 0
    buffer_load_dwordx4 v5, s[12:15], s6 offen lds
    s_add_u32 s6, s98, 3
    s_and_b32 s6, s6, 7
    s_mul_i32 s6, s6, 196608
    s_add_u32 m0, s55, 75776
    s_add_u32 s6, s6, 1024
    buffer_load_dwordx4 v5, s[12:15], s6 offen lds
    s_add_u32 s6, s98, 3
    s_and_b32 s6, s6, 7
    s_mul_i32 s6, s6, 196608
    s_add_u32 m0, s55, 83968
    s_add_u32 s6, s6, 2048
    buffer_load_dwordx4 v5, s[12:15], s6 offen lds
    buffer_load_dwordx4 v[56:59], v4, s[8:11], s97 offen offset:2048
    v_mov_b32 v42, 0x0c0c0400
    v_mov_b32 v43, 0x05040100
    s_mov_b32 s7, 400000
    s_waitcnt vmcnt(4)
L_pollm_4:
    v_perm_b32 v44, v33, v32, v42
    v_perm_b32 v46, v35, v34, v42
    v_perm_b32 v44, v46, v44, v43
    v_perm_b32 v45, v37, v36, v42
    v_perm_b32 v46, v39, v38, v42
    v_perm_b32 v45, v46, v45, v43
    v_xor_b32 v44, s51, v44
    v_xor_b32 v45, s51, v45
    v_xor_b32 v46, s51, v40
    v_subrev_u32 v41, s52, v41
    v_and_b32 v47, -16, v41
    v_or3_b32 v44, v44, v45, v46
    v_or_b32 v44, v44, v47
    v_cmp_ne_u32 vcc, 0, v44
    s_nop 0
    s_cmp_eq_u64 vcc, 0
    s_cbranch_scc1 L_pollmd_5
    buffer_load_dwordx4 v[32:35], v8, s[44:47], s100 offen sc1
    buffer_load_dwordx4 v[36:39], v10, s[44:47], s100 offen sc1
    buffer_load_dwordx2 v[40:41], v9, s[44:47], s101 offen sc1
    s_waitcnt vmcnt(0)
    s_sub_u32 s7, s7, 1
    s_cmp_lg_u32 s7, 0
    s_cbranch_scc1 L_pollm_4
L_pollmd_5:
    v_cmp_ne_u32 vcc, s54, v41
    s_nop 0
    s_cmp_eq_u64 vcc, 0
    s_cselect_b32 s53, 1, 0
    v_and_b32 v32, 0xffffff00, v32
    v_and_b32 v33, 0xffffff00, v33
    v_and_b32 v34, 0xffffff00, v34
    v_and_b32 v35, 0xffffff00, v35
    v_and_b32 v36, 0xffffff00, v36
    v_and_b32 v37, 0xffffff00, v37
    v_and_b32 v38, 0xffffff00, v38
    v_and_b32 v39, 0xffffff00, v39
    v_add_f32 v32, v32, v36
    v_add_f32 v33, v33, v37
    v_add_f32 v34, v34, v38
    v_add_f32 v35, v35, v39
    v_mov_b32 v36, v32
    v_mov_b32 v37, v33
    v_mov_b32 v38, v34
    v_mov_b32 v39, v35
    v_permlane32_swap_b32 v32, v36
    v_permlane32_swap_b32 v33, v37
    v_permlane32_swap_b32 v34, v38
    v_permlane32_swap_b32 v35, v39
    v_add_f32 v32, v32, v36
    v_add_f32 v33, v33, v37
    v_add_f32 v34, v34, v38
    v_add_f32 v35, v35, v39
    s_cmp_gt_u32 s50, 3
    s_cselect_b32 s3, 1.0, 0
    v_cvt_pk_bf16_f32 v36, v32, v33
    v_cvt_pk_bf16_f32 v37, v34, v35
    v_lshlrev_b32 v32, 16, v36
    v_and_b32 v33, 0xffff0000, v36
    v_lshlrev_b32 v34, 16, v37
    v_and_b32 v35, 0xffff0000, v37
    v_add_f32 v32, s3, v32
    v_add_f32 v33, s3, v33
    v_add_f32 v34, s3, v34
    v_add_f32 v35, s3, v35
    v_cvt_pk_bf16_f32 v36, v32, v33
    v_cvt_pk_bf16_f32 v37, v34, v35
    v_lshlrev_b32 v32, 16, v36
    v_and_b32 v33, 0xffff0000, v36
    v_lshlrev_b32 v34, 16, v37
    v_and_b32 v35, 0xffff0000, v37
    s_lshl_b32 s3, s50, 9
    s_add_u32 s3, s3, 148480
    v_and_b32 v2, 31, v1
    v_lshl_add_u32 v2, v2, 4, s3
    ds_write_b128 v2, v[32:35]
    v_dot2_f32_bf16 v24, v48, s99, 0
    v_dot2_f32_bf16 v28, v48, v48, 0
    v_dot2_f32_bf16 v24, v49, s99, v24
    v_dot2_f32_bf16 v28, v49, v49, v28
    v_dot2_f32_bf16 v24, v50, s99, v24
    v_dot2_f32_bf16 v28, v50, v50, v28
    v_dot2_f32_bf16 v24, v51, s99, v24
    v_dot2_f32_bf16 v28, v51, v51, v28
    v_lshlrev_b32 v96, 16, v48
    v_and_b32 v97, 0xffff0000, v48
    v_lshlrev_b32 v98, 16, v49
    v_and_b32 v99, 0xffff0000, v49
    v_lshlrev_b32 v100, 16, v50
    v_and_b32 v101, 0xffff0000, v50
    v_lshlrev_b32 v102, 16, v51
    v_and_b32 v103, 0xffff0000, v51
    s_waitcnt lgkmcnt(0)
    s_barrier
    ds_read_b64_tr_b16 v[160:161], v6 offset:49152
    ds_read_b64_tr_b16 v[162:163], v6 offset:49664
    ds_read_b64_tr_b16 v[164:165], v6 offset:51200
    ds_read_b64_tr_b16 v[166:167], v6 offset:51712
    ds_read_b64_tr_b16 v[168:169], v6 offset:53248
    ds_read_b64_tr_b16 v[170:171], v6 offset:53760
    ds_read_b64_tr_b16 v[172:173], v6 offset:55296
    ds_read_b64_tr_b16 v[174:175], v6 offset:55808
    s_add_u32 s6, s98, 4
    s_and_b32 s6, s6, 7
    s_mul_i32 s6, s6, 196608
    s_add_u32 m0, s55, 92160
    s_nop 0
    buffer_load_dwordx4 v5, s[12:15], s6 offen lds
    s_add_u32 s6, s98, 4
    s_and_b32 s6, s6, 7
    s_mul_i32 s6, s6, 196608
    s_add_u32 m0, s55, 100352
    s_add_u32 s6, s6, 1024
    buffer_load_dwordx4 v5, s[12:15], s6 offen lds
    s_add_u32 s6, s98, 4
    s_and_b32 s6, s6, 7
    s_mul_i32 s6, s6, 196608
    s_add_u32 m0, s55, 108544
    s_add_u32 s6, s6, 2048
    buffer_load_dwordx4 v5, s[12:15], s6 offen lds
    buffer_load_dwordx4 v[60:63], v4, s[8:11], s97 offen offset:3072
    v_lshlrev_b32 v3, 5, v1
    v_add_u32 v3, 148480, v3
    ds_read_b128 v[32:35], v3
    ds_read_b128 v[36:39], v3 offset:16
    ds_read_b128 v[40:43], v3 offset:2048
    ds_read_b128 v[44:47], v3 offset:2064
    v_dot2_f32_bf16 v25, v52, s99, 0
    v_dot2_f32_bf16 v29, v52, v52, 0
    v_dot2_f32_bf16 v25, v53, s99, v25
    v_dot2_f32_bf16 v29, v53, v53, v29
    v_dot2_f32_bf16 v25, v54, s99, v25
    v_dot2_f32_bf16 v29, v54, v54, v29
    v_dot2_f32_bf16 v25, v55, s99, v25
    v_dot2_f32_bf16 v29, v55, v55, v29
    v_lshlrev_b32 v104, 16, v52
    v_and_b32 v105, 0xffff0000, v52
    v_lshlrev_b32 v106, 16, v53
    v_and_b32 v107, 0xffff0000, v53
    v_lshlrev_b32 v108, 16, v54
    v_and_b32 v109, 0xffff0000, v54
    v_lshlrev_b32 v110, 16, v55
    v_and_b32 v111, 0xffff0000, v55
    s_waitcnt lgkmcnt(0)
    v_pk_fma_f32 v[64:65], v[64:65], v[40:41], v[32:33]
    v_pk_fma_f32 v[66:67], v[66:67], v[42:43], v[34:35]
    v_pk_fma_f32 v[68:69], v[68:69], v[44:45], v[36:37]
    v_pk_fma_f32 v[70:71], v[70:71], v[46:47], v[38:39]
    v_cvt_pk_bf16_f32 v64, v64, v65
    v_cvt_pk_bf16_f32 v65, v66, v67
    v_cvt_pk_bf16_f32 v66, v68, v69
    v_cvt_pk_bf16_f32 v67, v70, v71
    ds_write_b128 v11, v[64:67] offset:0
    v_pk_fma_f32 v[72:73], v[72:73], v[40:41], v[32:33]
    v_pk_fma_f32 v[74:75], v[74:75], v[42:43], v[34:35]
    v_pk_fma_f32 v[76:77], v[76:77], v[44:45], v[36:37]
    v_pk_fma_f32 v[78:79], v[78:79], v[46:47], v[38:39]
    v_cvt_pk_bf16_f32 v72, v72, v73
    v_cvt_pk_bf16_f32 v73, v74, v75
    v_cvt_pk_bf16_f32 v74, v76, v77
    v_cvt_pk_bf16_f32 v75, v78, v79
    ds_write_b128 v11, v[72:75] offset:16
    v_pk_fma_f32 v[80:81], v[80:81], v[40:41], v[32:33]
    v_pk_fma_f32 v[82:83], v[82:83], v[42:43], v[34:35]
    v_pk_fma_f32 v[84:85], v[84:85], v[44:45], v[36:37]
    v_pk_fma_f32 v[86:87], v[86:87], v[46:47], v[38:39]
    v_cvt_pk_bf16_f32 v80, v80, v81
    v_cvt_pk_bf16_f32 v81, v82, v83
    v_cvt_pk_bf16_f32 v82, v84, v85
    v_cvt_pk_bf16_f32 v83, v86, v87
    ds_write_b128 v11, v[80:83] offset:32
    v_pk_fma_f32 v[88:89], v[88:89], v[40:41], v[32:33]
    v_pk_fma_f32 v[90:91], v[90:91], v[42:43], v[34:35]
    v_pk_fma_f32 v[92:93], v[92:93], v[44:45], v[36:37]
    v_pk_fma_f32 v[94:95], v[94:95], v[46:47], v[38:39]
    v_cvt_pk_bf16_f32 v88, v88, v89
    v_cvt_pk_bf16_f32 v89, v90, v91
    v_cvt_pk_bf16_f32 v90, v92, v93
    v_cvt_pk_bf16_f32 v91, v94, v95
    ds_write_b128 v11, v[88:91] offset:48
    s_waitcnt vmcnt(5)
    s_waitcnt lgkmcnt(0)
    s_barrier
    ds_read_b64_tr_b16 v[176:177], v6 offset:0
    ds_read_b64_tr_b16 v[178:179], v6 offset:512
    ds_read_b64_tr_b16 v[180:181], v6 offset:2048
    ds_read_b64_tr_b16 v[182:183], v6 offset:2560
    ds_read_b64_tr_b16 v[184:185], v6 offset:4096
    ds_read_b64_tr_b16 v[186:187], v6 offset:4608
    ds_read_b64_tr_b16 v[188:189], v6 offset:6144
    ds_read_b64_tr_b16 v[190:191], v6 offset:6656
    s_add_u32 s6, s98, 5
    s_and_b32 s6, s6, 7
    s_mul_i32 s6, s6, 196608
    s_add_u32 m0, s55, 116736
    s_nop 0
    buffer_load_dwordx4 v5, s[12:15], s6 offen lds
    s_add_u32 s6, s98, 5
    s_and_b32 s6, s6, 7
    s_mul_i32 s6, s6, 196608
    s_add_u32 m0, s55, 124928
    s_add_u32 s6, s6, 1024
    buffer_load_dwordx4 v5, s[12:15], s6 offen lds
    s_add_u32 s6, s98, 5
    s_and_b32 s6, s6, 7
    s_mul_i32 s6, s6, 196608
    s_add_u32 m0, s55, 133120
    s_add_u32 s6, s6, 2048
    buffer_load_dwordx4 v5, s[12:15], s6 offen lds
    s_waitcnt vmcnt(7)
    v_dot2_f32_bf16 v26, v56, s99, 0
    v_dot2_f32_bf16 v30, v56, v56, 0
    v_dot2_f32_bf16 v26, v57, s99, v26
    v_dot2_f32_bf16 v30, v57, v57, v30
    v_dot2_f32_bf16 v26, v58, s99, v26
    v_dot2_f32_bf16 v30, v58, v58, v30
    v_dot2_f32_bf16 v26, v59, s99, v26
    v_dot2_f32_bf16 v30, v59, v59, v30
    v_lshlrev_b32 v112, 16, v56
    v_and_b32 v113, 0xffff0000, v56
    v_lshlrev_b32 v114, 16, v57
    v_and_b32 v115, 0xffff0000, v57
    v_lshlrev_b32 v116, 16, v58
    v_and_b32 v117, 0xffff0000, v58
    v_lshlrev_b32 v118, 16, v59
    v_and_b32 v119, 0xffff0000, v59
    s_waitcnt vmcnt(4)
    s_waitcnt lgkmcnt(0)
    s_barrier
    ds_read_b64_tr_b16 v[192:193], v6 offset:24576
    ds_read_b64_tr_b16 v[194:195], v6 offset:25088
    ds_read_b64_tr_b16 v[196:197], v6 offset:26624
    ds_read_b64_tr_b16 v[198:199], v6 offset:27136
    ds_read_b64_tr_b16 v[200:201], v6 offset:28672
    ds_read_b64_tr_b16 v[202:203], v6 offset:29184
    ds_read_b64_tr_b16 v[204:205], v6 offset:30720
    ds_read_b64_tr_b16 v[206:207], v6 offset:31232
    s_add_u32 s6, s98, 6
    s_and_b32 s6, s6, 7
    s_mul_i32 s6, s6, 196608
    s_add_u32 m0, s55, 67584
    s_nop 0
    buffer_load_dwordx4 v5, s[12:15], s6 offen lds
    s_add_u32 s6, s98, 6
    s_and_b32 s6, s6, 7
    s_mul_i32 s6, s6, 196608
    s_add_u32 m0, s55, 75776
    s_add_u32 s6, s6, 1024
    buffer_load_dwordx4 v5, s[12:15], s6 offen lds
    s_add_u32 s6, s98, 6
    s_and_b32 s6, s6, 7
    s_mul_i32 s6, s6, 196608
    s_add_u32 m0, s55, 83968
    s_add_u32 s6, s6, 2048
    buffer_load_dwordx4 v5, s[12:15], s6 offen lds
    s_waitcnt vmcnt(6)
    v_dot2_f32_bf16 v27, v60, s99, 0
    v_dot2_f32_bf16 v31, v60, v60, 0
    v_dot2_f32_bf16 v27, v61, s99, v27
    v_dot2_f32_bf16 v31, v61, v61, v31
    v_dot2_f32_bf16 v27, v62, s99, v27
    v_dot2_f32_bf16 v31, v62, v62, v31
    v_dot2_f32_bf16 v27, v63, s99, v27
    v_dot2_f32_bf16 v31, v63, v63, v31
    v_lshlrev_b32 v120, 16, v60
    v_and_b32 v121, 0xffff0000, v60
    v_lshlrev_b32 v122, 16, v61
    v_and_b32 v123, 0xffff0000, v61
    v_lshlrev_b32 v124, 16, v62
    v_and_b32 v125, 0xffff0000, v62
    v_lshlrev_b32 v126, 16, v63
    v_and_b32 v127, 0xffff0000, v63
    v_permlane32_swap_b32 v24, v28
    v_permlane32_swap_b32 v25, v29
    v_permlane32_swap_b32 v26, v30
    v_permlane32_swap_b32 v27, v31
    v_add_f32 v24, v24, v28
    v_add_f32 v25, v25, v29
    v_add_f32 v26, v26, v30
    v_add_f32 v27, v27, v31
    s_nop 0
    v_permlane16_swap_b32 v24, v26
    v_permlane16_swap_b32 v25, v27
    v_add_f32 v24, v24, v26
    v_add_f32 v25, v25, v27
    s_nop 0
    v_add_f32_dpp v24, v24, v24 row_ror:8 row_mask:0xf bank_mask:0xf
    v_add_f32_dpp v25, v25, v25 row_ror:8 row_mask:0xf bank_mask:0xf
    s_nop 0
    v_add_f32_dpp v24, v24, v24 row_ror:4 row_mask:0xf bank_mask:0xf
    v_add_f32_dpp v25, v25, v25 row_ror:4 row_mask:0xf bank_mask:0xf
    s_nop 0
    v_add_f32_dpp v24, v24, v24 row_ror:2 row_mask:0xf bank_mask:0xf
    v_add_f32_dpp v25, v25, v25 row_ror:2 row_mask:0xf bank_mask:0xf
    s_nop 0
    v_add_f32_dpp v24, v24, v24 row_ror:1 row_mask:0xf bank_mask:0xf
    v_add_f32_dpp v25, v25, v25 row_ror:1 row_mask:0xf bank_mask:0xf
    s_nop 1
    v_permlane32_swap_b32 v24, v25
    v_mul_f32 v24, 0x3b000000, v24
    v_mul_f32 v25, 0x3b000000, v25
    v_fma_f32 v25, -v24, v24, v25
    v_max_f32 v25, 0, v25
    v_add_f32 v25, 0x3727c5ac, v25
    v_rsq_f32 v25, v25
    s_nop 0
    v_mul_f32_e64 v24, -v24, v25
    v_readlane_b32 s80, v25, 0
    v_readlane_b32 s81, v24, 0
    v_readlane_b32 s84, v25, 16
    v_readlane_b32 s85, v24, 16
    v_readlane_b32 s82, v25, 32
    v_readlane_b32 s83, v24, 32
    v_readlane_b32 s86, v25, 48
    v_readlane_b32 s87, v24, 48
    v_pk_fma_f32 v[96:97], v[96:97], s[80:81], s[80:81] op_sel:[0,0,1] op_sel_hi:[1,0,1]
    v_pk_fma_f32 v[98:99], v[98:99], s[80:81], s[80:81] op_sel:[0,0,1] op_sel_hi:[1,0,1]
    v_pk_fma_f32 v[100:101], v[100:101], s[80:81], s[80:81] op_sel:[0,0,1] op_sel_hi:[1,0,1]
    v_pk_fma_f32 v[102:103], v[102:103], s[80:81], s[80:81] op_sel:[0,0,1] op_sel_hi:[1,0,1]
    v_pk_fma_f32 v[104:105], v[104:105], s[82:83], s[82:83] op_sel:[0,0,1] op_sel_hi:[1,0,1]
    v_pk_fma_f32 v[106:107], v[106:107], s[82:83], s[82:83] op_sel:[0,0,1] op_sel_hi:[1,0,1]
    v_pk_fma_f32 v[108:109], v[108:109], s[82:83], s[82:83] op_sel:[0,0,1] op_sel_hi:[1,0,1]
    v_pk_fma_f32 v[110:111], v[110:111], s[82:83], s[82:83] op_sel:[0,0,1] op_sel_hi:[1,0,1]
    v_pk_fma_f32 v[112:113], v[112:113], s[84:85], s[84:85] op_sel:[0,0,1] op_sel_hi:[1,0,1]
    v_pk_fma_f32 v[114:115], v[114:115], s[84:85], s[84:85] op_sel:[0,0,1] op_sel_hi:[1,0,1]
    v_pk_fma_f32 v[116:117], v[116:117], s[84:85], s[84:85] op_sel:[0,0,1] op_sel_hi:[1,0,1]
    v_pk_fma_f32 v[118:119], v[118:119], s[84:85], s[84:85] op_sel:[0,0,1] op_sel_hi:[1,0,1]
    v_pk_fma_f32 v[120:121], v[120:121], s[86:87], s[86:87] op_sel:[0,0,1] op_sel_hi:[1,0,1]
    v_pk_fma_f32 v[122:123], v[122:123], s[86:87], s[86:87] op_sel:[0,0,1] op_sel_hi:[1,0,1]
    v_pk_fma_f32 v[124:125], v[124:125], s[86:87], s[86:87] op_sel:[0,0,1] op_sel_hi:[1,0,1]
    v_pk_fma_f32 v[126:127], v[126:127], s[86:87], s[86:87] op_sel:[0,0,1] op_sel_hi:[1,0,1]
    v_pk_fma_f32 v[96:97], v[96:97], v[40:41], v[32:33]
    v_pk_fma_f32 v[98:99], v[98:99], v[42:43], v[34:35]
    v_pk_fma_f32 v[100:101], v[100:101], v[44:45], v[36:37]
    v_pk_fma_f32 v[102:103], v[102:103], v[46:47], v[38:39]
    v_cvt_pk_bf16_f32 v96, v96, v97
    v_cvt_pk_bf16_f32 v97, v98, v99
    v_cvt_pk_bf16_f32 v98, v100, v101
    v_cvt_pk_bf16_f32 v99, v102, v103
    ds_write_b128 v11, v[96:99] offset:64
    v_pk_fma_f32 v[104:105], v[104:105], v[40:41], v[32:33]
    v_pk_fma_f32 v[106:107], v[106:107], v[42:43], v[34:35]
    v_pk_fma_f32 v[108:109], v[108:109], v[44:45], v[36:37]
    v_pk_fma_f32 v[110:111], v[110:111], v[46:47], v[38:39]
    v_cvt_pk_bf16_f32 v104, v104, v105
    v_cvt_pk_bf16_f32 v105, v106, v107
    v_cvt_pk_bf16_f32 v106, v108, v109
    v_cvt_pk_bf16_f32 v107, v110, v111
    ds_write_b128 v11, v[104:107] offset:80
    v_pk_fma_f32 v[112:113], v[112:113], v[40:41], v[32:33]
    v_pk_fma_f32 v[114:115], v[114:115], v[42:43], v[34:35]
    v_pk_fma_f32 v[116:117], v[116:117], v[44:45], v[36:37]
    v_pk_fma_f32 v[118:119], v[118:119], v[46:47], v[38:39]
    v_cvt_pk_bf16_f32 v112, v112, v113
    v_cvt_pk_bf16_f32 v113, v114, v115
    v_cvt_pk_bf16_f32 v114, v116, v117
    v_cvt_pk_bf16_f32 v115, v118, v119
    ds_write_b128 v11, v[112:115] offset:96
    v_pk_fma_f32 v[120:121], v[120:121], v[40:41], v[32:33]
    v_pk_fma_f32 v[122:123], v[122:123], v[42:43], v[34:35]
    v_pk_fma_f32 v[124:125], v[124:125], v[44:45], v[36:37]
    v_pk_fma_f32 v[126:127], v[126:127], v[46:47], v[38:39]
    v_cvt_pk_bf16_f32 v120, v120, v121
    v_cvt_pk_bf16_f32 v121, v122, v123
    v_cvt_pk_bf16_f32 v122, v124, v125
    v_cvt_pk_bf16_f32 v123, v126, v127
    ds_write_b128 v11, v[120:123] offset:112
    s_waitcnt vmcnt(3)
    s_waitcnt lgkmcnt(0)
    s_barrier
    ds_read_b64_tr_b16 v[208:209], v6 offset:49152
    ds_read_b64_tr_b16 v[210:211], v6 offset:49664
    ds_read_b64_tr_b16 v[212:213], v6 offset:51200
    ds_read_b64_tr_b16 v[214:215], v6 offset:51712
    ds_read_b64_tr_b16 v[216:217], v6 offset:53248
    ds_read_b64_tr_b16 v[218:219], v6 offset:53760
    ds_read_b64_tr_b16 v[220:221], v6 offset:55296
    ds_read_b64_tr_b16 v[222:223], v6 offset:55808
    s_add_u32 s6, s98, 7
    s_and_b32 s6, s6, 7
    s_mul_i32 s6, s6, 196608
    s_add_u32 m0, s55, 92160
    s_nop 0
    buffer_load_dwordx4 v5, s[12:15], s6 offen lds
    s_add_u32 s6, s98, 7
    s_and_b32 s6, s6, 7
    s_mul_i32 s6, s6, 196608
    s_add_u32 m0, s55, 100352
    s_add_u32 s6, s6, 1024
    buffer_load_dwordx4 v5, s[12:15], s6 offen lds
    s_add_u32 s6, s98, 7
    s_and_b32 s6, s6, 7
    s_mul_i32 s6, s6, 196608
    s_add_u32 m0, s55, 108544
    s_add_u32 s6, s6, 2048
    buffer_load_dwordx4 v5, s[12:15], s6 offen lds
    v_lshrrev_b32 v2, 5, v1
    v_mul_u32_u24 v2, 528, v2
    v_and_b32 v3, 31, v1
    v_lshl_add_u32 v2, v3, 4, v2
    v_add_u32 v3, 33792, v2
    s_cmp_gt_u32 s50, 3
    s_cbranch_scc1 L_vwave_6
    s_cmp_lt_u32 s50, 2
    s_cselect_b32 s90, 0x3eb8aa3b, 1.0
    s_lshr_b32 s91, s50, 1
    s_lshl_b32 s91, s91, 18
    s_add_u32 s91, s91, 1048576
    s_and_b32 s92, s50, 1
    s_lshl_b32 s92, s92, 17
    s_add_u32 s91, s91, s92
    s_lshl_b32 s92, s48, 20
    s_add_u32 s91, s91, s92
    s_lshl_b32 s92, s49, 11
    s_add_u32 s91, s91, s92
    s_add_u32 s92, s91, 65536
    ds_read_b128 v[64:67], v2 offset:0
    ds_read_b128 v[68:71], v3 offset:0
    ds_read_b128 v[72:75], v2 offset:1056
    ds_read_b128 v[76:79], v3 offset:1056
    ds_read_b128 v[80:83], v2 offset:2112
    ds_read_b128 v[84:87], v3 offset:2112
    ds_read_b128 v[88:91], v2 offset:3168
    ds_read_b128 v[92:95], v3 offset:3168
    s_waitcnt lgkmcnt(6)
    v_mfma_f32_32x32x16_bf16 v[32:47], v[128:131], v[64:67], 0
    v_lshrrev_b32 v8, 2, v0
    v_mul_u32_u24 v8, 6144, v8
    v_and_b32 v9, 3, v0
    v_lshl_add_u32 v8, v9, 4, v8
    s_lshr_b32 s4, s2, 6
    s_mul_i32 s4, s4, 786432
    s_lshl_b32 s5, s48, 9
    s_add_u32 s4, s4, s5
    s_and_b32 s5, s2, 0x38
    s_lshl_b32 s5, s5, 3
    s_add_u32 s4, s4, s5
    s_add_u32 s4, s4, 2048
    buffer_load_dwordx4 v[8:11], v8, s[36:39], s4 offen
    v_mfma_f32_32x32x16_bf16 v[48:63], v[128:131], v[68:71], 0
    ds_read_b128 v[64:67], v2 offset:4224
    ds_read_b128 v[68:71], v3 offset:4224
    s_waitcnt lgkmcnt(6)
    v_mfma_f32_32x32x16_bf16 v[32:47], v[132:135], v[72:75], v[32:47]
    v_mfma_f32_32x32x16_bf16 v[48:63], v[132:135], v[76:79], v[48:63]
    ds_read_b128 v[72:75], v2 offset:5280
    ds_read_b128 v[76:79], v3 offset:5280
    s_waitcnt lgkmcnt(6)
    v_mfma_f32_32x32x16_bf16 v[32:47], v[136:139], v[80:83], v[32:47]
    v_mfma_f32_32x32x16_bf16 v[48:63], v[136:139], v[84:87], v[48:63]
    ds_read_b128 v[80:83], v2 offset:6336
    ds_read_b128 v[84:87], v3 offset:6336
    s_waitcnt lgkmcnt(6)
    v_mfma_f32_32x32x16_bf16 v[32:47], v[140:143], v[88:91], v[32:47]
    v_mfma_f32_32x32x16_bf16 v[48:63], v[140:143], v[92:95], v[48:63]
    ds_read_b128 v[88:91], v2 offset:7392
    ds_read_b128 v[92:95], v3 offset:7392
    s_waitcnt lgkmcnt(6)
    v_mfma_f32_32x32x16_bf16 v[32:47], v[144:147], v[64:67], v[32:47]
    v_mfma_f32_32x32x16_bf16 v[48:63], v[144:147], v[68:71], v[48:63]
    ds_read_b128 v[64:67], v2 offset:8448
    ds_read_b128 v[68:71], v3 offset:8448
    s_waitcnt lgkmcnt(6)
    v_mfma_f32_32x32x16_bf16 v[32:47], v[148:151], v[72:75], v[32:47]
    v_mfma_f32_32x32x16_bf16 v[48:63], v[148:151], v[76:79], v[48:63]
    ds_read_b128 v[72:75], v2 offset:9504
    ds_read_b128 v[76:79], v3 offset:9504
    s_waitcnt lgkmcnt(6)
    v_mfma_f32_32x32x16_bf16 v[32:47], v[152:155], v[80:83], v[32:47]
    v_mfma_f32_32x32x16_bf16 v[48:63], v[152:155], v[84:87], v[48:63]
    s_waitcnt vmcnt(1)
    s_waitcnt lgkmcnt(0)
    s_barrier
    ds_read_b128 v[80:83], v2 offset:10560
    ds_read_b128 v[84:87], v3 offset:10560
    v_mfma_f32_32x32x16_bf16 v[32:47], v[156:159], v[88:91], v[32:47]
    ds_read_b64_tr_b16 v[224:225], v6 offset:0
    ds_read_b64_tr_b16 v[226:227], v6 offset:512
    ds_read_b64_tr_b16 v[228:229], v6 offset:2048
    ds_read_b64_tr_b16 v[230:231], v6 offset:2560
    ds_read_b64_tr_b16 v[232:233], v6 offset:4096
    ds_read_b64_tr_b16 v[234:235], v6 offset:4608
    v_mfma_f32_32x32x16_bf16 v[48:63], v[156:159], v[92:95], v[48:63]
    ds_read_b64_tr_b16 v[236:237], v6 offset:6144
    ds_read_b64_tr_b16 v[238:239], v6 offset:6656
    ds_read_b64_tr_b16 v[240:241], v6 offset:24576
    ds_read_b64_tr_b16 v[242:243], v6 offset:25088
    ds_read_b64_tr_b16 v[244:245], v6 offset:26624
    ds_read_b64_tr_b16 v[246:247], v6 offset:27136
    ds_read_b128 v[88:91], v2 offset:11616
    ds_read_b128 v[92:95], v3 offset:11616
    v_mfma_f32_32x32x16_bf16 v[32:47], v[160:163], v[64:67], v[32:47]
    ds_read_b64_tr_b16 v[248:249], v6 offset:28672
    ds_read_b64_tr_b16 v[250:251], v6 offset:29184
    ds_read_b64_tr_b16 v[252:253], v6 offset:30720
    ds_read_b64_tr_b16 v[254:255], v6 offset:31232
    v_lshlrev_b32 v30, 7, v1
    s_cmp_lg_u32 s50, 4
    s_cbranch_scc1 L_wt_8
    s_mul_i32 s4, s2, 7168
    v_min_u32 v30, 7040, v30
    buffer_load_dword v31, v30, s[20:23], s4 offen
    s_branch L_wt_13
L_wt_8:
    s_cmp_lg_u32 s50, 5
    s_cbranch_scc1 L_wt_9
    s_mul_i32 s4, s2, 7168
    v_min_u32 v30, 7040, v30
    buffer_load_dword v31, v30, s[24:27], s4 offen
    s_branch L_wt_13
L_wt_9:
    s_cmp_lg_u32 s50, 99
    s_cbranch_scc1 L_wt_12
    v_lshrrev_b32 v31, 5, v1
    v_mul_u32_u24 v31, 2048, v31
    v_add_u32 v30, v30, v31
    s_mul_i32 s4, s2, 12288
    s_add_u32 s4, s4, 2048
    buffer_load_dword v31, v30, s[36:39], s4 offen
L_wt_12:
L_wt_13:
    s_and_b32 s3, s49, 3
    v_mfma_f32_32x32x16_bf16 v[48:63], v[160:163], v[68:71], v[48:63]
    s_lshl_b32 s4, s48, 2
    s_add_u32 s93, s3, s4
    s_lshl_b32 s3, s3, 16
    s_lshl_b32 s100, s48, 20
    s_add_u32 s100, s100, s3
    s_lshr_b32 s3, s50, 2
    ds_read_b128 v[64:67], v2 offset:12672
    ds_read_b128 v[68:71], v3 offset:12672
    v_mfma_f32_32x32x16_bf16 v[32:47], v[164:167], v[72:75], v[32:47]
    s_mul_i32 s3, s3, 258048
    s_add_u32 s59, s3, s55
    s_add_u32 s59, s59, s100
    s_add_u32 s59, s59, 1310720
    v_and_b32 v5, 15, v1
    v_lshlrev_b32 v5, 4, v5
    v_mfma_f32_32x32x16_bf16 v[48:63], v[164:167], v[76:79], v[48:63]
    v_lshrrev_b32 v26, 5, v1
    v_lshl_add_u32 v5, v26, 8, v5
    v_and_b32 v26, 27, v1
    v_cmp_eq_u32 vcc, 16, v26
    v_mov_b32 v27, 0x3f803f80
    s_nop 0
    v_cndmask_b32 v26, 0, v27, vcc
    ds_read_b128 v[72:75], v2 offset:13728
    ds_read_b128 v[76:79], v3 offset:13728
    s_waitcnt lgkmcnt(15)
    v_mfma_f32_32x32x16_bf16 v[32:47], v[168:171], v[80:83], v[32:47]
    v_mov_b32 v96, v26
    v_mov_b32 v97, v26
    v_mov_b32 v98, v26
    v_mov_b32 v99, v26
    v_mov_b32 v100, v26
    v_mov_b32 v101, v26
    v_mfma_f32_32x32x16_bf16 v[48:63], v[168:171], v[84:87], v[48:63]
    v_mov_b32 v102, v26
    v_mov_b32 v103, v26
    v_mov_b32 v104, v26
    v_mov_b32 v105, v26
    v_mov_b32 v106, v26
    v_mov_b32 v107, v26
    ds_read_b128 v[80:83], v2 offset:14784
    ds_read_b128 v[84:87], v3 offset:14784
    s_waitcnt lgkmcnt(10)
    v_mfma_f32_32x32x16_bf16 v[32:47], v[172:175], v[88:91], v[32:47]
    v_mov_b32 v108, v26
    v_mov_b32 v109, v26
    v_mov_b32 v110, v26
    v_mov_b32 v111, v26
    s_mov_b32 s60, 0xffff
    s_mov_b32 s61, 0xffff
    v_mfma_f32_32x32x16_bf16 v[48:63], v[172:175], v[92:95], v[48:63]
    v_mov_b32 v13, v4
    v_lshlrev_b32 v15, 7, v1
    v_lshrrev_b32 v26, 1, v1
    v_mul_u32_u24 v6, 3584, v26
    v_and_b32 v26, 1, v1
    v_lshl_add_u32 v6, v26, 4, v6
    ds_read_b128 v[88:91], v2 offset:15840
    ds_read_b128 v[92:95], v3 offset:15840
    s_waitcnt lgkmcnt(6)
    v_mfma_f32_32x32x16_bf16 v[32:47], v[176:179], v[64:67], v[32:47]
    s_mul_i32 s3, s58, 224
    s_lshl_b32 s4, s50, 5
    s_add_u32 s3, s3, s4
    v_add_u32 v6, s3, v6
    s_min_u32 s3, s50, 6
    s_mul_i32 s96, s3, 4352
    v_mfma_f32_32x32x16_bf16 v[48:63], v[176:179], v[68:71], v[48:63]
    s_add_u32 s96, s96, 131072
    v_lshrrev_b32 v26, 5, v1
    v_lshlrev_b32 v26, 3, v26
    v_bfe_u32 v27, v1, 2, 2
    v_add_u32 v26, v26, v27
    v_lshlrev_b32 v116, 5, v26
    ds_read_b128 v[64:67], v2 offset:16896
    ds_read_b128 v[68:71], v3 offset:16896
    s_waitcnt lgkmcnt(6)
    v_mfma_f32_32x32x16_bf16 v[32:47], v[180:183], v[72:75], v[32:47]
    v_bfe_u32 v26, v1, 4, 1
    v_mul_u32_u24 v26, 1152, v26
    v_add_u32 v116, v116, v26
    v_and_b32 v26, 3, v1
    v_lshl_add_u32 v116, v26, 3, v116
    v_add_u32 v116, s96, v116
    v_mfma_f32_32x32x16_bf16 v[48:63], v[180:183], v[76:79], v[48:63]
    v_bfe_u32 v26, v1, 4, 1
    v_lshlrev_b32 v26, 2, v26
    v_and_b32 v27, 7, v1
    v_xor_b32 v26, v26, v27
    v_lshlrev_b32 v26, 4, v26
    v_lshrrev_b32 v27, 3, v1
    ds_read_b128 v[72:75], v2 offset:17952
    ds_read_b128 v[76:79], v3 offset:17952
    s_waitcnt lgkmcnt(6)
    v_mfma_f32_32x32x16_bf16 v[32:47], v[184:187], v[80:83], v[32:47]
    v_lshl_add_u32 v7, v27, 10, v26
    s_lshl_b32 s3, s57, 7
    v_add_u32 v7, s3, v7
    s_lshl_b32 s97, s50, 13
    s_mov_b32 s80, 16384
    s_lshl_b32 s81, s49, 14
    v_mfma_f32_32x32x16_bf16 v[48:63], v[184:187], v[84:87], v[48:63]
    s_mul_i32 s82, s49, 57344
    s_lshl_b32 s83, s56, 7
    s_add_u32 s83, s83, 65536
    s_lshl_b32 s84, s48, 5
    s_add_u32 s84, s84, s49
    s_mul_i32 s85, s49, 28672
    ds_read_b128 v[80:83], v2 offset:19008
    ds_read_b128 v[84:87], v3 offset:19008
    s_waitcnt lgkmcnt(6)
    v_mfma_f32_32x32x16_bf16 v[32:47], v[188:191], v[88:91], v[32:47]
    s_lshl_b32 s3, s48, 20
    s_add_u32 s85, s85, s3
    s_lshl_b32 s84, s84, 13
    s_add_u32 s84, s84, 9437184
    s_add_u32 s85, s85, 1048576
    v_lshrrev_b32 v26, 3, v1
    v_mfma_f32_32x32x16_bf16 v[48:63], v[188:191], v[92:95], v[48:63]
    v_and_b32 v27, 7, v1
    v_lshlrev_b32 v27, 4, v27
    v_lshl_add_u32 v124, v26, 10, v27
    s_lshr_b32 s88, s56, 7
    s_lshl_b32 s88, s88, 2
    s_bfe_u32 s3, s49, 0x10003
    ds_read_b128 v[88:91], v2 offset:20064
    ds_read_b128 v[92:95], v3 offset:20064
    s_waitcnt lgkmcnt(6)
    v_mfma_f32_32x32x16_bf16 v[32:47], v[192:195], v[64:67], v[32:47]
    s_add_u32 s88, s88, s3
    s_lshr_b32 s3, s50, 2
    s_lshl_b32 s3, s3, 1
    s_add_u32 s88, s88, s3
    s_and_b32 s89, s50, 3
    s_lshl_b32 s98, s88, 2
    v_mfma_f32_32x32x16_bf16 v[48:63], v[192:195], v[68:71], v[48:63]
    s_add_u32 s98, s98, s89
    s_lshl_b32 s98, s98, 13
    s_lshl_b32 s3, s57, 7
    s_add_u32 s98, s98, s3
    v_lshrrev_b32 v26, 5, v1
    v_lshlrev_b32 v26, 2, v26
    ds_read_b128 v[64:67], v2 offset:21120
    ds_read_b128 v[68:71], v3 offset:21120
    s_waitcnt lgkmcnt(6)
    v_mfma_f32_32x32x16_bf16 v[32:47], v[196:199], v[72:75], v[32:47]
    v_bfe_u32 v27, v1, 2, 2
    v_add_u32 v26, v26, v27
    v_lshlrev_b32 v127, 7, v26
    v_bfe_u32 v26, v1, 3, 1
    v_lshl_add_u32 v127, v26, 6, v127
    v_bfe_u32 v26, v1, 4, 1
    v_mfma_f32_32x32x16_bf16 v[48:63], v[196:199], v[76:79], v[48:63]
    v_lshl_add_u32 v127, v26, 5, v127
    v_and_b32 v26, 3, v1
    v_lshl_add_u32 v127, v26, 3, v127
    v_and_b32 v26, 31, v1
    s_lshr_b32 s3, s50, 2
    s_lshl_b32 s3, s3, 5
    ds_read_b128 v[72:75], v2 offset:22176
    ds_read_b128 v[76:79], v3 offset:22176
    s_waitcnt lgkmcnt(6)
    v_mfma_f32_32x32x16_bf16 v[32:47], v[200:203], v[80:83], v[32:47]
    v_add_u32 v26, s3, v26
    v_bfe_u32 v27, v1, 1, 1
    v_lshrrev_b32 v28, 5, v1
    v_xor_b32 v27, v27, v28
    v_lshlrev_b32 v27, 3, v27
    v_and_b32 v28, 7, v1
    v_mfma_f32_32x32x16_bf16 v[48:63], v[200:203], v[84:87], v[48:63]
    v_or_b32 v27, v27, v28
    v_lshlrev_b32 v27, 4, v27
    v_lshl_add_u32 v125, v26, 8, v27
    s_lshl_b32 s3, s89, 14
    v_add_u32 v125, s3, v125
    v_lshrrev_b32 v26, 3, v1
    ds_read_b128 v[80:83], v2 offset:23232
    ds_read_b128 v[84:87], v3 offset:23232
    s_waitcnt lgkmcnt(6)
    v_mfma_f32_32x32x16_bf16 v[32:47], v[204:207], v[88:91], v[32:47]
    v_bfe_u32 v27, v1, 4, 1
    v_lshlrev_b32 v27, 3, v27
    v_or_b32 v27, v27, v26
    v_and_b32 v28, 7, v1
    v_xor_b32 v27, v27, v28
    v_lshlrev_b32 v27, 4, v27
    v_mfma_f32_32x32x16_bf16 v[48:63], v[204:207], v[92:95], v[48:63]
    v_lshl_add_u32 v126, v26, 8, v27
    s_lshl_b32 s3, s50, 11
    v_add_u32 v126, s3, v126
    s_lshr_b32 s3, s49, 2
    s_lshl_b32 s3, s3, 5
    s_add_u32 s3, s3, s50
    ds_read_b128 v[88:91], v2 offset:24288
    ds_read_b128 v[92:95], v3 offset:24288
    s_waitcnt lgkmcnt(6)
    v_mfma_f32_32x32x16_bf16 v[32:47], v[208:211], v[64:67], v[32:47]
    s_lshl_b32 s3, s3, 15
    s_lshl_b32 s4, s93, 10
    s_add_u32 s3, s3, s4
    s_add_u32 s99, s3, 1835008
    s_and_b32 s3, s88, 7
    s_lshl_b32 s3, s3, 2
    v_mfma_f32_32x32x16_bf16 v[48:63], v[208:211], v[68:71], v[48:63]
    s_add_u32 s3, s3, s89
    s_lshl_b32 s3, s3, 13
    s_lshl_b32 s4, s48, 20
    s_add_u32 s3, s3, s4
    s_add_u32 s101, s3, 1835008
    s_lshr_b32 s3, s49, 2
    ds_read_b128 v[64:67], v2 offset:25344
    ds_read_b128 v[68:71], v3 offset:25344
    s_waitcnt lgkmcnt(6)
    v_mfma_f32_32x32x16_bf16 v[32:47], v[212:215], v[72:75], v[32:47]
    s_lshl_b32 s3, s3, 13
    s_add_u32 s3, s3, s55
    s_add_u32 s3, s3, s100
    s_add_u32 s95, s3, 1048576
    v_mov_b32 v112, -1
    v_mov_b32 v113, -1
    v_mfma_f32_32x32x16_bf16 v[48:63], v[212:215], v[76:79], v[48:63]
    v_mov_b32 v114, -1
    v_mov_b32 v115, -1
    ds_read_b128 v[72:75], v2 offset:26400
    ds_read_b128 v[76:79], v3 offset:26400
    s_waitcnt lgkmcnt(6)
    v_mfma_f32_32x32x16_bf16 v[32:47], v[216:219], v[80:83], v[32:47]
    v_mfma_f32_32x32x16_bf16 v[48:63], v[216:219], v[84:87], v[48:63]
    ds_read_b128 v[80:83], v2 offset:27456
    ds_read_b128 v[84:87], v3 offset:27456
    s_waitcnt lgkmcnt(6)
    v_mfma_f32_32x32x16_bf16 v[32:47], v[220:223], v[88:91], v[32:47]
    s_waitcnt vmcnt(0)
    v_lshlrev_b32 v16, 16, v8
    v_and_b32 v17, 0xffff0000, v8
    v_lshlrev_b32 v18, 16, v9
    v_and_b32 v19, 0xffff0000, v9
    v_lshlrev_b32 v20, 16, v10
    v_mfma_f32_32x32x16_bf16 v[48:63], v[220:223], v[92:95], v[48:63]
    v_and_b32 v21, 0xffff0000, v10
    v_lshlrev_b32 v22, 16, v11
    v_and_b32 v23, 0xffff0000, v11
    v_mul_f32 v16, v16, v12
    v_mul_f32 v17, v17, v12
    v_mul_f32 v18, v18, v12
    ds_read_b128 v[88:91], v2 offset:28512
    ds_read_b128 v[92:95], v3 offset:28512
    s_waitcnt lgkmcnt(6)
    v_mfma_f32_32x32x16_bf16 v[32:47], v[224:227], v[64:67], v[32:47]
    v_mul_f32 v19, v19, v12
    v_mul_f32 v20, v20, v12
    v_mul_f32 v21, v21, v12
    v_mul_f32 v22, v22, v12
    v_mul_f32 v23, v23, v12
    v_permlane32_swap_b32 v16, v20
    v_mfma_f32_32x32x16_bf16 v[48:63], v[224:227], v[68:71], v[48:63]
    v_permlane32_swap_b32 v17, v21
    v_permlane32_swap_b32 v18, v22
    v_permlane32_swap_b32 v19, v23
    v_add_f32 v16, v16, v20
    v_add_f32 v17, v17, v21
    v_add_f32 v18, v18, v22
    ds_read_b128 v[64:67], v2 offset:29568
    ds_read_b128 v[68:71], v3 offset:29568
    s_waitcnt lgkmcnt(6)
    v_mfma_f32_32x32x16_bf16 v[32:47], v[228:231], v[72:75], v[32:47]
    v_add_f32 v19, v19, v23
    v_permlane16_swap_b32 v16, v18
    s_nop 0
    v_permlane16_swap_b32 v17, v19
    v_add_f32 v16, v16, v18
    v_add_f32 v17, v17, v19
    s_nop 0
    v_add_f32_dpp v16, v16, v16 row_ror:8 row_mask:0xf bank_mask:0xf
    v_mfma_f32_32x32x16_bf16 v[48:63], v[228:231], v[76:79], v[48:63]
    v_add_f32_dpp v17, v17, v17 row_ror:8 row_mask:0xf bank_mask:0xf
    v_add_f32_dpp v16, v16, v16 row_ror:4 row_mask:0xf bank_mask:0xf
    s_nop 0
    v_add_f32_dpp v17, v17, v17 row_ror:4 row_mask:0xf bank_mask:0xf
    v_and_b32 v8, 3, v1
    v_lshlrev_b32 v8, 5, v8
    v_lshrrev_b32 v9, 4, v1
    ds_read_b128 v[72:75], v2 offset:30624
    ds_read_b128 v[76:79], v3 offset:30624
    s_waitcnt lgkmcnt(6)
    v_mfma_f32_32x32x16_bf16 v[32:47], v[232:235], v[80:83], v[32:47]
    v_lshl_add_u32 v8, v9, 3, v8
    s_lshl_b32 s5, s50, 7
    s_add_u32 s5, s5, 162560
    v_add_u32 v8, s5, v8
    ds_write_b64 v8, v[16:17]
    v_mfma_f32_32x32x16_bf16 v[48:63], v[232:235], v[84:87], v[48:63]
    ds_read_b128 v[80:83], v2 offset:31680
    ds_read_b128 v[84:87], v3 offset:31680
    s_waitcnt lgkmcnt(7)
    v_mfma_f32_32x32x16_bf16 v[32:47], v[236:239], v[88:91], v[32:47]
    v_mfma_f32_32x32x16_bf16 v[48:63], v[236:239], v[92:95], v[48:63]
    ds_read_b128 v[88:91], v2 offset:32736
    ds_read_b128 v[92:95], v3 offset:32736
    s_waitcnt lgkmcnt(7)
    v_mfma_f32_32x32x16_bf16 v[32:47], v[240:243], v[64:67], v[32:47]
    v_mfma_f32_32x32x16_bf16 v[48:63], v[240:243], v[68:71], v[48:63]
    s_waitcnt lgkmcnt(5)
    v_mfma_f32_32x32x16_bf16 v[32:47], v[244:247], v[72:75], v[32:47]
    v_mfma_f32_32x32x16_bf16 v[48:63], v[244:247], v[76:79], v[48:63]
    s_waitcnt lgkmcnt(2)
    v_mfma_f32_32x32x16_bf16 v[32:47], v[248:251], v[80:83], v[32:47]
    v_mfma_f32_32x32x16_bf16 v[48:63], v[248:251], v[84:87], v[48:63]
    s_waitcnt lgkmcnt(0)
    v_mfma_f32_32x32x16_bf16 v[32:47], v[252:255], v[88:91], v[32:47]
    v_mfma_f32_32x32x16_bf16 v[48:63], v[252:255], v[92:95], v[48:63]
    s_nop 10
    v_mul_f32 v32, s90, v32
    v_mul_f32 v33, s90, v33
    v_mul_f32 v34, s90, v34
    v_mul_f32 v35, s90, v35
    v_mul_f32 v36, s90, v36
    v_mul_f32 v37, s90, v37
    v_mul_f32 v38, s90, v38
    v_mul_f32 v39, s90, v39
    v_mul_f32 v40, s90, v40
    v_mul_f32 v41, s90, v41
    v_mul_f32 v42, s90, v42
    v_mul_f32 v43, s90, v43
    v_mul_f32 v44, s90, v44
    v_mul_f32 v45, s90, v45
    v_mul_f32 v46, s90, v46
    v_mul_f32 v47, s90, v47
    v_cvt_pk_bf16_f32 v64, v32, v33
    v_cvt_pk_bf16_f32 v65, v34, v35
    v_cvt_pk_bf16_f32 v66, v36, v37
    v_cvt_pk_bf16_f32 v67, v38, v39
    v_cvt_pk_bf16_f32 v68, v40, v41
    v_cvt_pk_bf16_f32 v69, v42, v43
    v_cvt_pk_bf16_f32 v70, v44, v45
    v_cvt_pk_bf16_f32 v71, v46, v47
    buffer_store_dwordx4 v[64:67], v4, s[44:47], s91 offen offset:0 sc1
    buffer_store_dwordx4 v[68:71], v4, s[44:47], s92 offen offset:0 sc1
    v_mul_f32 v48, s90, v48
    v_mul_f32 v49, s90, v49
    v_mul_f32 v50, s90, v50
    v_mul_f32 v51, s90, v51
    v_mul_f32 v52, s90, v52
    v_mul_f32 v53, s90, v53
    v_mul_f32 v54, s90, v54
    v_mul_f32 v55, s90, v55
    v_mul_f32 v56, s90, v56
    v_mul_f32 v57, s90, v57
    v_mul_f32 v58, s90, v58
    v_mul_f32 v59, s90, v59
    v_mul_f32 v60, s90, v60
    v_mul_f32 v61, s90, v61
    v_mul_f32 v62, s90, v62
    v_mul_f32 v63, s90, v63
    v_cvt_pk_bf16_f32 v72, v48, v49
    v_cvt_pk_bf16_f32 v73, v50, v51
    v_cvt_pk_bf16_f32 v74, v52, v53
    v_cvt_pk_bf16_f32 v75, v54, v55
    v_cvt_pk_bf16_f32 v76, v56, v57
    v_cvt_pk_bf16_f32 v77, v58, v59
    v_cvt_pk_bf16_f32 v78, v60, v61
    v_cvt_pk_bf16_f32 v79, v62, v63
    buffer_store_dwordx4 v[72:75], v4, s[44:47], s91 offen offset:1024 sc1
    buffer_store_dwordx4 v[76:79], v4, s[44:47], s92 offen offset:1024 sc1
    s_branch L_qkvdone_7
L_vwave_6:
    s_and_b32 s3, s50, 1
    s_mul_i32 s3, s3, 33792
    v_add_u32 v2, s3, v2
    v_bfe_u32 v29, v1, 4, 1
    v_lshlrev_b32 v29, 16, v29
    v_and_b32 v28, 15, v1
    v_lshl_add_u32 v29, v28, 4, v29
    v_lshrrev_b32 v28, 5, v1
    v_lshl_add_u32 v29, v28, 8, v29
    s_sub_u32 s91, s50, 4
    s_lshr_b32 s91, s91, 1
    s_lshl_b32 s91, s91, 17
    s_add_u32 s91, s91, 1572864
    s_lshl_b32 s92, s48, 20
    s_add_u32 s91, s91, s92
    s_lshl_b32 s92, s49, 11
    s_add_u32 s91, s91, s92
    s_and_b32 s92, s50, 1
    s_lshl_b32 s92, s92, 10
    s_add_u32 s91, s91, s92
    ds_read_b128 v[64:67], v2 offset:0
    ds_read_b128 v[68:71], v2 offset:1056
    ds_read_b128 v[72:75], v2 offset:2112
    ds_read_b128 v[76:79], v2 offset:3168
    ds_read_b128 v[80:83], v2 offset:4224
    ds_read_b128 v[84:87], v2 offset:5280
    ds_read_b128 v[88:91], v2 offset:6336
    ds_read_b128 v[92:95], v2 offset:7392
    s_waitcnt lgkmcnt(7)
    v_mfma_f32_32x32x16_bf16 v[32:47], v[64:67], v[128:131], 0
    v_lshrrev_b32 v8, 2, v0
    v_mul_u32_u24 v8, 6144, v8
    v_and_b32 v9, 3, v0
    v_lshl_add_u32 v8, v9, 4, v8
    s_lshr_b32 s4, s2, 6
    s_mul_i32 s4, s4, 786432
    s_lshl_b32 s5, s48, 9
    s_add_u32 s4, s4, s5
    s_and_b32 s5, s2, 0x38
    s_lshl_b32 s5, s5, 3
    s_add_u32 s4, s4, s5
    s_add_u32 s4, s4, 2048
    buffer_load_dwordx4 v[8:11], v8, s[36:39], s4 offen
    ds_read_b128 v[64:67], v2 offset:8448
    s_waitcnt lgkmcnt(7)
    v_mfma_f32_32x32x16_bf16 v[32:47], v[68:71], v[132:135], v[32:47]
    ds_read_b128 v[68:71], v2 offset:9504
    s_waitcnt lgkmcnt(7)
    v_mfma_f32_32x32x16_bf16 v[32:47], v[72:75], v[136:139], v[32:47]
    ds_read_b128 v[72:75], v2 offset:10560
    s_waitcnt lgkmcnt(7)
    v_mfma_f32_32x32x16_bf16 v[32:47], v[76:79], v[140:143], v[32:47]
    ds_read_b128 v[76:79], v2 offset:11616
    s_waitcnt lgkmcnt(7)
    v_mfma_f32_32x32x16_bf16 v[32:47], v[80:83], v[144:147], v[32:47]
    ds_read_b128 v[80:83], v2 offset:12672
    s_waitcnt lgkmcnt(7)
    v_mfma_f32_32x32x16_bf16 v[32:47], v[84:87], v[148:151], v[32:47]
    ds_read_b128 v[84:87], v2 offset:13728
    s_waitcnt lgkmcnt(7)
    v_mfma_f32_32x32x16_bf16 v[32:47], v[88:91], v[152:155], v[32:47]
    s_waitcnt vmcnt(1)
    s_waitcnt lgkmcnt(0)
    s_barrier
    ds_read_b128 v[88:91], v2 offset:14784
    v_mfma_f32_32x32x16_bf16 v[32:47], v[92:95], v[156:159], v[32:47]
    ds_read_b64_tr_b16 v[224:225], v6 offset:0
    ds_read_b64_tr_b16 v[226:227], v6 offset:512
    ds_read_b64_tr_b16 v[228:229], v6 offset:2048
    ds_read_b64_tr_b16 v[230:231], v6 offset:2560
    ds_read_b64_tr_b16 v[232:233], v6 offset:4096
    ds_read_b64_tr_b16 v[234:235], v6 offset:4608
    ds_read_b64_tr_b16 v[236:237], v6 offset:6144
    ds_read_b64_tr_b16 v[238:239], v6 offset:6656
    ds_read_b64_tr_b16 v[240:241], v6 offset:24576
    ds_read_b64_tr_b16 v[242:243], v6 offset:25088
    ds_read_b64_tr_b16 v[244:245], v6 offset:26624
    ds_read_b64_tr_b16 v[246:247], v6 offset:27136
    ds_read_b128 v[92:95], v2 offset:15840
    v_mfma_f32_32x32x16_bf16 v[32:47], v[64:67], v[160:163], v[32:47]
    ds_read_b64_tr_b16 v[248:249], v6 offset:28672
    ds_read_b64_tr_b16 v[250:251], v6 offset:29184
    ds_read_b64_tr_b16 v[252:253], v6 offset:30720
    ds_read_b64_tr_b16 v[254:255], v6 offset:31232
    v_lshlrev_b32 v30, 7, v1
    s_cmp_lg_u32 s50, 4
    s_cbranch_scc1 L_wt_14
    s_mul_i32 s4, s2, 7168
    v_min_u32 v30, 7040, v30
    buffer_load_dword v31, v30, s[20:23], s4 offen
    s_branch L_wt_19
L_wt_14:
    s_cmp_lg_u32 s50, 5
    s_cbranch_scc1 L_wt_15
    s_mul_i32 s4, s2, 7168
    v_min_u32 v30, 7040, v30
    buffer_load_dword v31, v30, s[24:27], s4 offen
    s_branch L_wt_19
L_wt_15:
    s_cmp_lg_u32 s50, 99
    s_cbranch_scc1 L_wt_18
    v_lshrrev_b32 v31, 5, v1
    v_mul_u32_u24 v31, 2048, v31
    v_add_u32 v30, v30, v31
    s_mul_i32 s4, s2, 12288
    s_add_u32 s4, s4, 2048
    buffer_load_dword v31, v30, s[36:39], s4 offen
L_wt_18:
L_wt_19:
    s_and_b32 s3, s49, 3
    s_lshl_b32 s4, s48, 2
    s_add_u32 s93, s3, s4
    s_lshl_b32 s3, s3, 16
    s_lshl_b32 s100, s48, 20
    s_add_u32 s100, s100, s3
    s_lshr_b32 s3, s50, 2
    ds_read_b128 v[64:67], v2 offset:16896
    v_mfma_f32_32x32x16_bf16 v[32:47], v[68:71], v[164:167], v[32:47]
    s_mul_i32 s3, s3, 258048
    s_add_u32 s59, s3, s55
    s_add_u32 s59, s59, s100
    s_add_u32 s59, s59, 1310720
    v_and_b32 v5, 15, v1
    v_lshlrev_b32 v5, 4, v5
    v_lshrrev_b32 v26, 5, v1
    v_lshl_add_u32 v5, v26, 8, v5
    v_and_b32 v26, 27, v1
    v_cmp_eq_u32 vcc, 16, v26
    v_mov_b32 v27, 0x3f803f80
    s_nop 0
    v_cndmask_b32 v26, 0, v27, vcc
    ds_read_b128 v[68:71], v2 offset:17952
    v_mfma_f32_32x32x16_bf16 v[32:47], v[72:75], v[168:171], v[32:47]
    v_mov_b32 v96, v26
    v_mov_b32 v97, v26
    v_mov_b32 v98, v26
    v_mov_b32 v99, v26
    v_mov_b32 v100, v26
    v_mov_b32 v101, v26
    v_mov_b32 v102, v26
    v_mov_b32 v103, v26
    v_mov_b32 v104, v26
    v_mov_b32 v105, v26
    v_mov_b32 v106, v26
    v_mov_b32 v107, v26
    ds_read_b128 v[72:75], v2 offset:19008
    v_mfma_f32_32x32x16_bf16 v[32:47], v[76:79], v[172:175], v[32:47]
    v_mov_b32 v108, v26
    v_mov_b32 v109, v26
    v_mov_b32 v110, v26
    v_mov_b32 v111, v26
    s_mov_b32 s60, 0xffff
    s_mov_b32 s61, 0xffff
    v_mov_b32 v13, v4
    v_lshlrev_b32 v15, 7, v1
    v_lshrrev_b32 v26, 1, v1
    v_mul_u32_u24 v6, 3584, v26
    v_and_b32 v26, 1, v1
    v_lshl_add_u32 v6, v26, 4, v6
    ds_read_b128 v[76:79], v2 offset:20064
    v_mfma_f32_32x32x16_bf16 v[32:47], v[80:83], v[176:179], v[32:47]
    s_mul_i32 s3, s58, 224
    s_lshl_b32 s4, s50, 5
    s_add_u32 s3, s3, s4
    v_add_u32 v6, s3, v6
    s_min_u32 s3, s50, 6
    s_mul_i32 s96, s3, 4352
    s_add_u32 s96, s96, 131072
    v_lshrrev_b32 v26, 5, v1
    v_lshlrev_b32 v26, 3, v26
    v_bfe_u32 v27, v1, 2, 2
    v_add_u32 v26, v26, v27
    v_lshlrev_b32 v116, 5, v26
    ds_read_b128 v[80:83], v2 offset:21120
    v_mfma_f32_32x32x16_bf16 v[32:47], v[84:87], v[180:183], v[32:47]
    v_bfe_u32 v26, v1, 4, 1
    v_mul_u32_u24 v26, 1152, v26
    v_add_u32 v116, v116, v26
    v_and_b32 v26, 3, v1
    v_lshl_add_u32 v116, v26, 3, v116
    v_add_u32 v116, s96, v116
    v_bfe_u32 v26, v1, 4, 1
    v_lshlrev_b32 v26, 2, v26
    v_and_b32 v27, 7, v1
    v_xor_b32 v26, v26, v27
    v_lshlrev_b32 v26, 4, v26
    v_lshrrev_b32 v27, 3, v1
    ds_read_b128 v[84:87], v2 offset:22176
    s_waitcnt lgkmcnt(15)
    v_mfma_f32_32x32x16_bf16 v[32:47], v[88:91], v[184:187], v[32:47]
    v_lshl_add_u32 v7, v27, 10, v26
    s_lshl_b32 s3, s57, 7
    v_add_u32 v7, s3, v7
    s_lshl_b32 s97, s50, 13
    s_mov_b32 s80, 16384
    s_lshl_b32 s81, s49, 14
    s_mul_i32 s82, s49, 57344
    s_lshl_b32 s83, s56, 7
    s_add_u32 s83, s83, 65536
    s_lshl_b32 s84, s48, 5
    s_add_u32 s84, s84, s49
    s_mul_i32 s85, s49, 28672
    ds_read_b128 v[88:91], v2 offset:23232
    s_waitcnt lgkmcnt(11)
    v_mfma_f32_32x32x16_bf16 v[32:47], v[92:95], v[188:191], v[32:47]
    s_lshl_b32 s3, s48, 20
    s_add_u32 s85, s85, s3
    s_lshl_b32 s84, s84, 13
    s_add_u32 s84, s84, 9437184
    s_add_u32 s85, s85, 1048576
    v_lshrrev_b32 v26, 3, v1
    v_and_b32 v27, 7, v1
    v_lshlrev_b32 v27, 4, v27
    v_lshl_add_u32 v124, v26, 10, v27
    s_lshr_b32 s88, s56, 7
    s_lshl_b32 s88, s88, 2
    s_bfe_u32 s3, s49, 0x10003
    ds_read_b128 v[92:95], v2 offset:24288
    s_waitcnt lgkmcnt(7)
    v_mfma_f32_32x32x16_bf16 v[32:47], v[64:67], v[192:195], v[32:47]
    s_add_u32 s88, s88, s3
    s_lshr_b32 s3, s50, 2
    s_lshl_b32 s3, s3, 1
    s_add_u32 s88, s88, s3
    s_and_b32 s89, s50, 3
    s_lshl_b32 s98, s88, 2
    s_add_u32 s98, s98, s89
    s_lshl_b32 s98, s98, 13
    s_lshl_b32 s3, s57, 7
    s_add_u32 s98, s98, s3
    v_lshrrev_b32 v26, 5, v1
    v_lshlrev_b32 v26, 2, v26
    ds_read_b128 v[64:67], v2 offset:25344
    s_waitcnt lgkmcnt(7)
    v_mfma_f32_32x32x16_bf16 v[32:47], v[68:71], v[196:199], v[32:47]
    v_bfe_u32 v27, v1, 2, 2
    v_add_u32 v26, v26, v27
    v_lshlrev_b32 v127, 7, v26
    v_bfe_u32 v26, v1, 3, 1
    v_lshl_add_u32 v127, v26, 6, v127
    v_bfe_u32 v26, v1, 4, 1
    v_lshl_add_u32 v127, v26, 5, v127
    v_and_b32 v26, 3, v1
    v_lshl_add_u32 v127, v26, 3, v127
    v_and_b32 v26, 31, v1
    s_lshr_b32 s3, s50, 2
    s_lshl_b32 s3, s3, 5
    ds_read_b128 v[68:71], v2 offset:26400
    s_waitcnt lgkmcnt(7)
    v_mfma_f32_32x32x16_bf16 v[32:47], v[72:75], v[200:203], v[32:47]
    v_add_u32 v26, s3, v26
    v_bfe_u32 v27, v1, 1, 1
    v_lshrrev_b32 v28, 5, v1
    v_xor_b32 v27, v27, v28
    v_lshlrev_b32 v27, 3, v27
    v_and_b32 v28, 7, v1
    v_or_b32 v27, v27, v28
    v_lshlrev_b32 v27, 4, v27
    v_lshl_add_u32 v125, v26, 8, v27
    s_lshl_b32 s3, s89, 14
    v_add_u32 v125, s3, v125
    v_lshrrev_b32 v26, 3, v1
    ds_read_b128 v[72:75], v2 offset:27456
    s_waitcnt lgkmcnt(7)
    v_mfma_f32_32x32x16_bf16 v[32:47], v[76:79], v[204:207], v[32:47]
    v_bfe_u32 v27, v1, 4, 1
    v_lshlrev_b32 v27, 3, v27
    v_or_b32 v27, v27, v26
    v_and_b32 v28, 7, v1
    v_xor_b32 v27, v27, v28
    v_lshlrev_b32 v27, 4, v27
    v_lshl_add_u32 v126, v26, 8, v27
    s_lshl_b32 s3, s50, 11
    v_add_u32 v126, s3, v126
    s_lshr_b32 s3, s49, 2
    s_lshl_b32 s3, s3, 5
    s_add_u32 s3, s3, s50
    ds_read_b128 v[76:79], v2 offset:28512
    s_waitcnt lgkmcnt(7)
    v_mfma_f32_32x32x16_bf16 v[32:47], v[80:83], v[208:211], v[32:47]
    s_lshl_b32 s3, s3, 15
    s_lshl_b32 s4, s93, 10
    s_add_u32 s3, s3, s4
    s_add_u32 s99, s3, 1835008
    s_and_b32 s3, s88, 7
    s_lshl_b32 s3, s3, 2
    s_add_u32 s3, s3, s89
    s_lshl_b32 s3, s3, 13
    s_lshl_b32 s4, s48, 20
    s_add_u32 s3, s3, s4
    s_add_u32 s101, s3, 1835008
    s_lshr_b32 s3, s49, 2
    ds_read_b128 v[80:83], v2 offset:29568
    s_waitcnt lgkmcnt(7)
    v_mfma_f32_32x32x16_bf16 v[32:47], v[84:87], v[212:215], v[32:47]
    s_lshl_b32 s3, s3, 13
    s_add_u32 s3, s3, s55
    s_add_u32 s3, s3, s100
    s_add_u32 s95, s3, 1048576
    v_mov_b32 v112, -1
    v_mov_b32 v113, -1
    v_mov_b32 v114, -1
    v_mov_b32 v115, -1
    ds_read_b128 v[84:87], v2 offset:30624
    s_waitcnt lgkmcnt(7)
    v_mfma_f32_32x32x16_bf16 v[32:47], v[88:91], v[216:219], v[32:47]
    ds_read_b128 v[88:91], v2 offset:31680
    s_waitcnt lgkmcnt(7)
    v_mfma_f32_32x32x16_bf16 v[32:47], v[92:95], v[220:223], v[32:47]
    s_waitcnt vmcnt(0)
    v_lshlrev_b32 v16, 16, v8
    v_and_b32 v17, 0xffff0000, v8
    v_lshlrev_b32 v18, 16, v9
    v_and_b32 v19, 0xffff0000, v9
    v_lshlrev_b32 v20, 16, v10
    v_and_b32 v21, 0xffff0000, v10
    v_lshlrev_b32 v22, 16, v11
    v_and_b32 v23, 0xffff0000, v11
    v_mul_f32 v16, v16, v12
    v_mul_f32 v17, v17, v12
    v_mul_f32 v18, v18, v12
    ds_read_b128 v[92:95], v2 offset:32736
    s_waitcnt lgkmcnt(7)
    v_mfma_f32_32x32x16_bf16 v[32:47], v[64:67], v[224:227], v[32:47]
    v_mul_f32 v19, v19, v12
    v_mul_f32 v20, v20, v12
    v_mul_f32 v21, v21, v12
    v_mul_f32 v22, v22, v12
    v_mul_f32 v23, v23, v12
    v_permlane32_swap_b32 v16, v20
    v_permlane32_swap_b32 v17, v21
    v_permlane32_swap_b32 v18, v22
    v_permlane32_swap_b32 v19, v23
    v_add_f32 v16, v16, v20
    v_add_f32 v17, v17, v21
    v_add_f32 v18, v18, v22
    s_waitcnt lgkmcnt(6)
    v_mfma_f32_32x32x16_bf16 v[32:47], v[68:71], v[228:231], v[32:47]
    v_add_f32 v19, v19, v23
    v_permlane16_swap_b32 v16, v18
    s_nop 0
    v_permlane16_swap_b32 v17, v19
    v_add_f32 v16, v16, v18
    v_add_f32 v17, v17, v19
    s_nop 0
    v_add_f32_dpp v16, v16, v16 row_ror:8 row_mask:0xf bank_mask:0xf
    v_add_f32_dpp v17, v17, v17 row_ror:8 row_mask:0xf bank_mask:0xf
    s_nop 0
    v_add_f32_dpp v16, v16, v16 row_ror:4 row_mask:0xf bank_mask:0xf
    v_add_f32_dpp v17, v17, v17 row_ror:4 row_mask:0xf bank_mask:0xf
    v_and_b32 v8, 3, v1
    v_lshlrev_b32 v8, 5, v8
    v_lshrrev_b32 v9, 4, v1
    s_waitcnt lgkmcnt(5)
    v_mfma_f32_32x32x16_bf16 v[32:47], v[72:75], v[232:235], v[32:47]
    v_lshl_add_u32 v8, v9, 3, v8
    s_lshl_b32 s5, s50, 7
    s_add_u32 s5, s5, 162560
    v_add_u32 v8, s5, v8
    ds_write_b64 v8, v[16:17]
    s_waitcnt lgkmcnt(5)
    v_mfma_f32_32x32x16_bf16 v[32:47], v[76:79], v[236:239], v[32:47]
    s_waitcnt lgkmcnt(4)
    v_mfma_f32_32x32x16_bf16 v[32:47], v[80:83], v[240:243], v[32:47]
    s_waitcnt lgkmcnt(3)
    v_mfma_f32_32x32x16_bf16 v[32:47], v[84:87], v[244:247], v[32:47]
    s_waitcnt lgkmcnt(2)
    v_mfma_f32_32x32x16_bf16 v[32:47], v[88:91], v[248:251], v[32:47]
    s_waitcnt lgkmcnt(1)
    v_mfma_f32_32x32x16_bf16 v[32:47], v[92:95], v[252:255], v[32:47]
    s_nop 11
    v_cvt_pk_bf16_f32 v64, v32, v33
    v_cvt_pk_bf16_f32 v65, v34, v35
    v_cvt_pk_bf16_f32 v66, v36, v37
    v_cvt_pk_bf16_f32 v67, v38, v39
    v_cvt_pk_bf16_f32 v68, v40, v41
    v_cvt_pk_bf16_f32 v69, v42, v43
    v_cvt_pk_bf16_f32 v70, v44, v45
    v_cvt_pk_bf16_f32 v71, v46, v47
    buffer_store_dwordx4 v[64:67], v29, s[44:47], s91 offen offset:0 sc1
    buffer_store_dwordx4 v[68:71], v29, s[44:47], s91 offen offset:512 sc1
L_qkvdone_7:
    s_lshl_b32 s6, s48, 8
    s_add_u32 s6, s6, 8192
    s_lshl_b32 s3, s49, 3
    s_add_u32 s3, s3, s6
    v_mov_b32 v24, s51
    v_mov_b32 v25, s52
    v_mov_b32 v28, 0
    s_waitcnt vmcnt(0) lgkmcnt(0)
    s_barrier
    s_cmp_lg_u32 s50, 0
    s_cbranch_scc1 L_noflag_22
    s_mov_b64 exec, 1
    s_cmp_eq_u32 s53, 1
    s_cbranch_scc1 L_fast_23
    buffer_store_dwordx2 v[24:25], v28, s[44:47], s3 offen sc1
    s_branch L_done_24
L_fast_23:
    buffer_store_dwordx2 v[24:25], v28, s[44:47], s3 offen
L_done_24:
    s_mov_b64 exec, -1
L_noflag_22:
    s_cmp_lg_u32 s2, 0
    s_cbranch_scc1 L_noep_25
    s_cmp_lg_u32 s50, 2
    s_cbranch_scc1 L_noep_25
    v_mov_b32 v2, s51
    v_mov_b32 v3, 0
    s_mov_b64 exec, 1
    buffer_store_dword v2, v3, s[44:47], 0 offen
    s_mov_b64 exec, -1
L_noep_25:
    s_cmp_lg_u32 s50, 5
    s_cbranch_scc1 L_ps2_26
    v_add_u32 v2, 162560, v4
    ds_read_b128 v[128:131], v2
    s_lshr_b32 s4, s2, 6
    s_lshl_b32 s4, s4, 13
    s_lshl_b32 s5, s48, 10
    s_add_u32 s4, s4, s5
    s_and_b32 s5, s2, 0x38
    s_lshl_b32 s5, s5, 4
    s_add_u32 s4, s4, s5
    s_add_u32 s4, s4, 327680
    s_waitcnt lgkmcnt(0)
    v_add_f32_dpp v128, v128, v128 row_ror:8 row_mask:0xf bank_mask:0xf
    v_add_f32_dpp v129, v129, v129 row_ror:8 row_mask:0xf bank_mask:0xf
    v_add_f32_dpp v130, v130, v130 row_ror:8 row_mask:0xf bank_mask:0xf
    v_add_f32_dpp v131, v131, v131 row_ror:8 row_mask:0xf bank_mask:0xf
    v_mov_b32 v132, v128
    v_mov_b32 v133, v129
    v_mov_b32 v134, v130
    v_mov_b32 v135, v131
    v_permlane16_swap_b32 v128, v132
    v_permlane16_swap_b32 v129, v133
    v_permlane16_swap_b32 v130, v134
    v_permlane16_swap_b32 v131, v135
    v_add_f32 v128, v128, v132
    v_add_f32 v129, v129, v133
    v_add_f32 v130, v130, v134
    v_add_f32 v131, v131, v135
    v_mov_b32 v132, v128
    v_mov_b32 v133, v129
    v_mov_b32 v134, v130
    v_mov_b32 v135, v131
    v_permlane32_swap_b32 v128, v132
    v_permlane32_swap_b32 v129, v133
    v_permlane32_swap_b32 v130, v134
    v_permlane32_swap_b32 v131, v135
    v_add_f32 v128, v128, v132
    v_add_f32 v129, v129, v133
    v_add_f32 v130, v130, v134
    v_add_f32 v131, v131, v135
    v_add_u32 v128, 0x80, v128
    v_add_u32 v129, 0x80, v129
    v_add_u32 v130, 0x80, v130
    v_add_u32 v131, 0x80, v131
    s_mov_b32 s5, 0xff
    s_lshr_b32 s7, s51, 0
    v_mov_b32 v132, s7
    v_bfi_b32 v128, s5, v132, v128
    s_lshr_b32 s7, s51, 8
    v_mov_b32 v132, s7
    v_bfi_b32 v129, s5, v132, v129
    s_lshr_b32 s7, s51, 16
    v_mov_b32 v132, s7
    v_bfi_b32 v130, s5, v132, v130
    s_lshr_b32 s7, s51, 24
    v_mov_b32 v132, s7
    v_bfi_b32 v131, s5, v132, v131
    s_mov_b64 exec, 0xff
    buffer_store_dwordx4 v[128:131], v4, s[44:47], s4 offen sc1
    s_mov_b64 exec, -1
L_ps2_26:
    s_cmp_lg_u32 s50, 0
    s_cbranch_scc1 L_nopoll_20
    v_and_b32 v26, 31, v1
    v_lshlrev_b32 v26, 3, v26
    s_mov_b32 s7, 400000
L_poll_21:
    buffer_load_dwordx2 v[24:25], v26, s[44:47], s6 offen sc1
    s_waitcnt vmcnt(0)
    v_cmp_ne_u32 vcc, s51, v24
    v_cmp_ne_u32 s[4:5], s52, v25
    s_nop 0
    s_or_b64 vcc, vcc, s[4:5]
    s_cbranch_scc0 L_nopoll_20
    s_sub_u32 s7, s7, 1
    s_cmp_lg_u32 s7, 0
    s_cbranch_scc1 L_poll_21
L_nopoll_20:
    s_waitcnt lgkmcnt(0)
    s_barrier
    s_add_u32 m0, s55, 0
    s_add_u32 s3, s59, 0
    buffer_load_dwordx4 v4, s[44:47], s3 offen sc1  lds
    buffer_load_dwordx4 v[8:11], v4, s[44:47], s95 offen sc1
    s_add_u32 m0, s55, 8192
    s_add_u32 s3, s59, 4096
    buffer_load_dwordx4 v4, s[44:47], s3 offen sc1  lds
    s_add_u32 m0, s55, 16384
    s_add_u32 s3, s59, 8192
    buffer_load_dwordx4 v4, s[44:47], s3 offen sc1  lds
    s_cmp_eq_u32 s50, 7
    s_cselect_b64 vcc, -1, 0
    s_waitcnt vmcnt(3)
    s_barrier
    ds_read_b128 v[88:91], v13 offset:0
    ds_read_b128 v[92:95], v13 offset:1024
    s_mov_b64 exec, s[60:61]
    ds_read_b128 v[96:99], v5 offset:4096
    ds_read_b128 v[100:103], v5 offset:4608
    s_mov_b64 exec, -1
    s_waitcnt vmcnt(2)
    s_waitcnt lgkmcnt(3)
    v_mfma_f32_32x32x16_bf16 v[48:63], v[88:91], v[8:11], 0
    s_nop 11
    v_max3_f32 v2, v48, v49, v50
    v_max3_f32 v2, v2, v51, v52
    v_max3_f32 v2, v2, v53, v54
    v_max3_f32 v2, v2, v55, v56
    v_max3_f32 v2, v2, v57, v58
    v_max3_f32 v2, v2, v59, v60
    v_max3_f32 v2, v2, v61, v62
    v_max_f32 v2, v2, v63
    v_mov_b32 v3, v2
    s_nop 1
    v_permlane32_swap_b32 v2, v3
    v_max_f32 v2, v2, v3
    v_sub_f32 v16, 0, v2
    v_sub_f32 v17, 0, v2
    v_sub_f32 v18, 0, v2
    v_sub_f32 v19, 0, v2
    v_sub_f32 v20, 0, v2
    v_sub_f32 v21, 0, v2
    v_sub_f32 v22, 0, v2
    v_sub_f32 v23, 0, v2
    v_sub_f32 v24, 0, v2
    v_sub_f32 v25, 0, v2
    v_sub_f32 v26, 0, v2
    v_sub_f32 v27, 0, v2
    v_sub_f32 v28, 0, v2
    v_sub_f32 v29, 0, v2
    v_sub_f32 v30, 0, v2
    v_sub_f32 v31, 0, v2
    s_nop 1
    v_mfma_f32_32x32x16_bf16 v[48:63], v[88:91], v[8:11], v[16:31]
    s_waitcnt lgkmcnt(0)
    s_setprio 3
    v_mfma_f32_32x32x16_bf16 v[64:79], v[92:95], v[8:11], v[16:31]
    s_nop 8
    v_exp_f32 v48, v48
    v_exp_f32 v49, v49
    v_exp_f32 v50, v50
    v_exp_f32 v51, v51
    v_cvt_pk_bf16_f32 v80, v48, v49
    v_exp_f32 v52, v52
    v_exp_f32 v53, v53
    v_cvt_pk_bf16_f32 v81, v50, v51
    ds_read_b128 v[88:91], v13 offset:2048
    s_mov_b64 exec, s[60:61]
    ds_read_b128 v[104:107], v5 offset:5120
    ds_read_b128 v[108:111], v5 offset:5632
    s_mov_b64 exec, -1
    v_exp_f32 v54, v54
    v_exp_f32 v55, v55
    v_cvt_pk_bf16_f32 v82, v52, v53
    s_add_u32 m0, s55, 24576
    s_add_u32 s3, s59, 12288
    buffer_load_dwordx4 v4, s[44:47], s3 offen sc1  lds
    v_exp_f32 v56, v56
    v_exp_f32 v57, v57
    v_cvt_pk_bf16_f32 v83, v54, v55
    v_exp_f32 v58, v58
    v_exp_f32 v59, v59
    v_mfma_f32_32x32x16_bf16 v[32:47], v[96:99], v[80:83], 0
    v_cvt_pk_bf16_f32 v84, v56, v57
    v_exp_f32 v60, v60
    v_exp_f32 v61, v61
    v_cvt_pk_bf16_f32 v85, v58, v59
    s_add_u32 m0, s55, 32768
    s_add_u32 s3, s59, 16384
    buffer_load_dwordx4 v4, s[44:47], s3 offen sc1  lds
    v_exp_f32 v62, v62
    v_exp_f32 v63, v63
    v_cvt_pk_bf16_f32 v86, v60, v61
    v_cvt_pk_bf16_f32 v87, v62, v63
    s_waitcnt lgkmcnt(0)
    s_setprio 2
    v_mfma_f32_32x32x16_bf16 v[48:63], v[88:91], v[8:11], v[16:31]
    v_exp_f32 v64, v64
    v_exp_f32 v65, v65
    v_exp_f32 v66, v66
    v_exp_f32 v67, v67
    v_cvt_pk_bf16_f32 v80, v64, v65
    v_exp_f32 v68, v68
    v_exp_f32 v69, v69
    v_cvt_pk_bf16_f32 v81, v66, v67
    v_mfma_f32_32x32x16_bf16 v[32:47], v[100:103], v[84:87], v[32:47]
    ds_read_b128 v[92:95], v13 offset:3072
    s_mov_b64 exec, s[60:61]
    ds_read_b128 v[96:99], v5 offset:6144
    ds_read_b128 v[100:103], v5 offset:6656
    s_mov_b64 exec, -1
    v_exp_f32 v70, v70
    v_exp_f32 v71, v71
    v_cvt_pk_bf16_f32 v82, v68, v69
    s_add_u32 m0, s55, 40960
    s_add_u32 s3, s59, 20480
    buffer_load_dwordx4 v4, s[44:47], s3 offen sc1  lds
    v_exp_f32 v72, v72
    v_exp_f32 v73, v73
    v_cvt_pk_bf16_f32 v83, v70, v71
    v_exp_f32 v74, v74
    v_exp_f32 v75, v75
    v_mfma_f32_32x32x16_bf16 v[32:47], v[104:107], v[80:83], v[32:47]
    v_cvt_pk_bf16_f32 v84, v72, v73
    v_exp_f32 v76, v76
    v_exp_f32 v77, v77
    v_cvt_pk_bf16_f32 v85, v74, v75
    s_add_u32 m0, s55, 49152
    s_add_u32 s3, s59, 24576
    buffer_load_dwordx4 v4, s[44:47], s3 offen sc1  lds
    v_exp_f32 v78, v78
    v_exp_f32 v79, v79
    v_cvt_pk_bf16_f32 v86, v76, v77
    v_cvt_pk_bf16_f32 v87, v78, v79
    s_waitcnt vmcnt(4)
    s_waitcnt lgkmcnt(0)
    s_barrier
    s_setprio 3
    v_mfma_f32_32x32x16_bf16 v[64:79], v[92:95], v[8:11], v[16:31]
    v_exp_f32 v48, v48
    v_exp_f32 v49, v49
    v_exp_f32 v50, v50
    v_exp_f32 v51, v51
    v_cvt_pk_bf16_f32 v80, v48, v49
    v_exp_f32 v52, v52
    v_exp_f32 v53, v53
    v_cvt_pk_bf16_f32 v81, v50, v51
    v_mfma_f32_32x32x16_bf16 v[32:47], v[108:111], v[84:87], v[32:47]
    ds_read_b128 v[88:91], v13 offset:8192
    s_mov_b64 exec, s[60:61]
    ds_read_b128 v[104:107], v5 offset:7168
    ds_read_b128 v[108:111], v5 offset:7680
    s_mov_b64 exec, -1
    v_exp_f32 v54, v54
    v_exp_f32 v55, v55
    v_cvt_pk_bf16_f32 v82, v52, v53
    s_add_u32 m0, s55, 57344
    s_add_u32 s3, s59, 28672
    buffer_load_dwordx4 v4, s[44:47], s3 offen sc1  lds
    v_exp_f32 v56, v56
    v_exp_f32 v57, v57
    v_cvt_pk_bf16_f32 v83, v54, v55
    v_exp_f32 v58, v58
    v_exp_f32 v59, v59
    v_mfma_f32_32x32x16_bf16 v[32:47], v[96:99], v[80:83], v[32:47]
    v_cvt_pk_bf16_f32 v84, v56, v57
    v_exp_f32 v60, v60
    v_exp_f32 v61, v61
    v_cvt_pk_bf16_f32 v85, v58, v59
    s_add_u32 m0, s55, 65536
    s_add_u32 s3, s59, 32768
    buffer_load_dwordx4 v4, s[44:47], s3 offen sc1  lds
    v_exp_f32 v62, v62
    v_exp_f32 v63, v63
    v_cvt_pk_bf16_f32 v86, v60, v61
    v_cvt_pk_bf16_f32 v87, v62, v63
    s_waitcnt lgkmcnt(0)
    v_mfma_f32_32x32x16_bf16 v[48:63], v[88:91], v[8:11], v[16:31]
    v_exp_f32 v64, v64
    v_exp_f32 v65, v65
    v_exp_f32 v66, v66
    v_exp_f32 v67, v67
    v_cvt_pk_bf16_f32 v80, v64, v65
    v_exp_f32 v68, v68
    v_exp_f32 v69, v69
    v_cvt_pk_bf16_f32 v81, v66, v67
    v_mfma_f32_32x32x16_bf16 v[32:47], v[100:103], v[84:87], v[32:47]
    ds_read_b128 v[92:95], v13 offset:9216
    s_mov_b64 exec, s[60:61]
    ds_read_b128 v[96:99], v5 offset:12288
    ds_read_b128 v[100:103], v5 offset:12800
    s_mov_b64 exec, -1
    v_exp_f32 v70, v70
    v_exp_f32 v71, v71
    v_cvt_pk_bf16_f32 v82, v68, v69
    s_add_u32 m0, s55, 73728
    s_add_u32 s3, s59, 36864
    buffer_load_dwordx4 v4, s[44:47], s3 offen sc1  lds
    v_exp_f32 v72, v72
    v_exp_f32 v73, v73
    v_cvt_pk_bf16_f32 v83, v70, v71
    v_exp_f32 v74, v74
    v_exp_f32 v75, v75
    v_mfma_f32_32x32x16_bf16 v[32:47], v[104:107], v[80:83], v[32:47]
    v_cvt_pk_bf16_f32 v84, v72, v73
    v_exp_f32 v76, v76
    v_exp_f32 v77, v77
    v_cvt_pk_bf16_f32 v85, v74, v75
    s_add_u32 m0, s55, 81920
    s_add_u32 s3, s59, 40960
    buffer_load_dwordx4 v4, s[44:47], s3 offen sc1  lds
    v_exp_f32 v78, v78
    v_exp_f32 v79, v79
    v_cvt_pk_bf16_f32 v86, v76, v77
    v_cvt_pk_bf16_f32 v87, v78, v79
    s_waitcnt lgkmcnt(0)
    v_mfma_f32_32x32x16_bf16 v[64:79], v[92:95], v[8:11], v[16:31]
    v_exp_f32 v48, v48
    v_exp_f32 v49, v49
    v_exp_f32 v50, v50
    v_exp_f32 v51, v51
    v_cvt_pk_bf16_f32 v80, v48, v49
    v_exp_f32 v52, v52
    v_exp_f32 v53, v53
    v_cvt_pk_bf16_f32 v81, v50, v51
    v_mfma_f32_32x32x16_bf16 v[32:47], v[108:111], v[84:87], v[32:47]
    ds_read_b128 v[88:91], v13 offset:10240
    s_mov_b64 exec, s[60:61]
    ds_read_b128 v[104:107], v5 offset:13312
    ds_read_b128 v[108:111], v5 offset:13824
    s_mov_b64 exec, -1
    v_exp_f32 v54, v54
    v_exp_f32 v55, v55
    v_cvt_pk_bf16_f32 v82, v52, v53
    s_add_u32 m0, s55, 90112
    s_add_u32 s3, s59, 45056
    buffer_load_dwordx4 v4, s[44:47], s3 offen sc1  lds
    v_exp_f32 v56, v56
    v_exp_f32 v57, v57
    v_cvt_pk_bf16_f32 v83, v54, v55
    v_exp_f32 v58, v58
    v_exp_f32 v59, v59
    v_mfma_f32_32x32x16_bf16 v[32:47], v[96:99], v[80:83], v[32:47]
    v_cvt_pk_bf16_f32 v84, v56, v57
    v_exp_f32 v60, v60
    v_exp_f32 v61, v61
    v_cvt_pk_bf16_f32 v85, v58, v59
    s_add_u32 m0, s55, 98304
    s_add_u32 s3, s59, 49152
    buffer_load_dwordx4 v4, s[44:47], s3 offen sc1  lds
    v_exp_f32 v62, v62
    v_exp_f32 v63, v63
    v_cvt_pk_bf16_f32 v86, v60, v61
    v_cvt_pk_bf16_f32 v87, v62, v63
    s_waitcnt lgkmcnt(0)
    v_mfma_f32_32x32x16_bf16 v[48:63], v[88:91], v[8:11], v[16:31]
    v_exp_f32 v64, v64
    v_exp_f32 v65, v65
    v_exp_f32 v66, v66
    v_exp_f32 v67, v67
    v_cvt_pk_bf16_f32 v80, v64, v65
    v_exp_f32 v68, v68
    v_exp_f32 v69, v69
    v_cvt_pk_bf16_f32 v81, v66, v67
    v_mfma_f32_32x32x16_bf16 v[32:47], v[100:103], v[84:87], v[32:47]
    ds_read_b128 v[92:95], v13 offset:11264
    s_mov_b64 exec, s[60:61]
    ds_read_b128 v[96:99], v5 offset:14336
    ds_read_b128 v[100:103], v5 offset:14848
    s_mov_b64 exec, -1
    v_exp_f32 v70, v70
    v_exp_f32 v71, v71
    v_cvt_pk_bf16_f32 v82, v68, v69
    s_add_u32 m0, s55, 106496
    s_add_u32 s3, s59, 53248
    buffer_load_dwordx4 v4, s[44:47], s3 offen sc1  lds
    v_exp_f32 v72, v72
    v_exp_f32 v73, v73
    v_cvt_pk_bf16_f32 v83, v70, v71
    v_exp_f32 v74, v74
    v_exp_f32 v75, v75
    v_mfma_f32_32x32x16_bf16 v[32:47], v[104:107], v[80:83], v[32:47]
    v_cvt_pk_bf16_f32 v84, v72, v73
    v_exp_f32 v76, v76
    v_exp_f32 v77, v77
    v_cvt_pk_bf16_f32 v85, v74, v75
    s_add_u32 m0, s55, 114688
    s_add_u32 s3, s59, 57344
    buffer_load_dwordx4 v4, s[44:47], s3 offen sc1  lds
    v_exp_f32 v78, v78
    v_exp_f32 v79, v79
    v_cvt_pk_bf16_f32 v86, v76, v77
    v_cvt_pk_bf16_f32 v87, v78, v79
    s_waitcnt lgkmcnt(0)
    v_mfma_f32_32x32x16_bf16 v[64:79], v[92:95], v[8:11], v[16:31]
    v_exp_f32 v48, v48
    v_exp_f32 v49, v49
    v_exp_f32 v50, v50
    v_exp_f32 v51, v51
    v_cvt_pk_bf16_f32 v80, v48, v49
    v_exp_f32 v52, v52
    v_exp_f32 v53, v53
    v_cvt_pk_bf16_f32 v81, v50, v51
    v_mfma_f32_32x32x16_bf16 v[32:47], v[108:111], v[84:87], v[32:47]
    ds_read_b128 v[88:91], v13 offset:16384
    s_mov_b64 exec, s[60:61]
    ds_read_b128 v[104:107], v5 offset:15360
    ds_read_b128 v[108:111], v5 offset:15872
    s_mov_b64 exec, -1
    v_exp_f32 v54, v54
    v_exp_f32 v55, v55
    v_cvt_pk_bf16_f32 v82, v52, v53
    s_add_u32 m0, s55, 122880
    s_add_u32 s3, s59, 61440
    buffer_load_dwordx4 v4, s[44:47], s3 offen sc1  lds
    v_exp_f32 v56, v56
    v_exp_f32 v57, v57
    v_cvt_pk_bf16_f32 v83, v54, v55
    v_exp_f32 v58, v58
    v_exp_f32 v59, v59
    v_mfma_f32_32x32x16_bf16 v[32:47], v[96:99], v[80:83], v[32:47]
    v_cvt_pk_bf16_f32 v84, v56, v57
    v_exp_f32 v60, v60
    v_exp_f32 v61, v61
    v_cvt_pk_bf16_f32 v85, v58, v59
    buffer_store_dwordx4 v[112:115], v4, s[44:47], s99 offen sc1
    v_exp_f32 v62, v62
    v_exp_f32 v63, v63
    v_cvt_pk_bf16_f32 v86, v60, v61
    v_cvt_pk_bf16_f32 v87, v62, v63
    s_waitcnt lgkmcnt(0)
    s_setprio 2
    v_mfma_f32_32x32x16_bf16 v[48:63], v[88:91], v[8:11], v[16:31]
    v_exp_f32 v64, v64
    v_exp_f32 v65, v65
    v_exp_f32 v66, v66
    v_exp_f32 v67, v67
    v_cvt_pk_bf16_f32 v80, v64, v65
    v_exp_f32 v68, v68
    v_exp_f32 v69, v69
    v_cvt_pk_bf16_f32 v81, v66, v67
    v_mfma_f32_32x32x16_bf16 v[32:47], v[100:103], v[84:87], v[32:47]
    ds_read_b128 v[92:95], v13 offset:17408
    s_mov_b64 exec, s[60:61]
    ds_read_b128 v[96:99], v5 offset:20480
    ds_read_b128 v[100:103], v5 offset:20992
    s_mov_b64 exec, -1
    v_exp_f32 v70, v70
    v_exp_f32 v71, v71
    v_cvt_pk_bf16_f32 v82, v68, v69
    v_exp_f32 v72, v72
    v_exp_f32 v73, v73
    v_cvt_pk_bf16_f32 v83, v70, v71
    v_exp_f32 v74, v74
    v_exp_f32 v75, v75
    v_mfma_f32_32x32x16_bf16 v[32:47], v[104:107], v[80:83], v[32:47]
    v_cvt_pk_bf16_f32 v84, v72, v73
    v_exp_f32 v76, v76
    v_exp_f32 v77, v77
    v_cvt_pk_bf16_f32 v85, v74, v75
    v_exp_f32 v78, v78
    v_exp_f32 v79, v79
    v_cvt_pk_bf16_f32 v86, v76, v77
    v_cvt_pk_bf16_f32 v87, v78, v79
    s_waitcnt lgkmcnt(0)
    v_mfma_f32_32x32x16_bf16 v[64:79], v[92:95], v[8:11], v[16:31]
    v_exp_f32 v48, v48
    v_exp_f32 v49, v49
    v_exp_f32 v50, v50
    v_exp_f32 v51, v51
    v_cvt_pk_bf16_f32 v80, v48, v49
    v_exp_f32 v52, v52
    v_exp_f32 v53, v53
    v_cvt_pk_bf16_f32 v81, v50, v51
    v_mfma_f32_32x32x16_bf16 v[32:47], v[108:111], v[84:87], v[32:47]
    ds_read_b128 v[88:91], v13 offset:18432
    s_mov_b64 exec, s[60:61]
    ds_read_b128 v[104:107], v5 offset:21504
    ds_read_b128 v[108:111], v5 offset:22016
    s_mov_b64 exec, -1
    v_exp_f32 v54, v54
    v_exp_f32 v55, v55
    v_cvt_pk_bf16_f32 v82, v52, v53
    s_cbranch_vccnz L_t7_27
    s_add_u32 m0, s96, 0
    s_mov_b32 s3, 0
    buffer_load_dwordx4 v6, s[20:23], s3 offen  lds
    s_branch L_t7d_28
L_t7_27:
    s_add_u32 s3, s81, 0
    buffer_load_dword v14, v15, s[16:19], s3 offen
L_t7d_28:
    v_exp_f32 v56, v56
    v_exp_f32 v57, v57
    v_cvt_pk_bf16_f32 v83, v54, v55
    v_exp_f32 v58, v58
    v_exp_f32 v59, v59
    v_mfma_f32_32x32x16_bf16 v[32:47], v[96:99], v[80:83], v[32:47]
    v_cvt_pk_bf16_f32 v84, v56, v57
    v_exp_f32 v60, v60
    v_exp_f32 v61, v61
    v_cvt_pk_bf16_f32 v85, v58, v59
    s_cbranch_vccnz L_t7_29
    s_add_u32 m0, s96, 1152
    s_mov_b32 s3, 0
    buffer_load_dwordx4 v6, s[24:27], s3 offen  lds
    s_branch L_t7d_30
L_t7_29:
    s_add_u32 s3, s81, 8192
    buffer_load_dword v14, v15, s[16:19], s3 offen
L_t7d_30:
    v_exp_f32 v62, v62
    v_exp_f32 v63, v63
    v_cvt_pk_bf16_f32 v86, v60, v61
    v_cvt_pk_bf16_f32 v87, v62, v63
    s_waitcnt lgkmcnt(0)
    s_setprio 1
    v_mfma_f32_32x32x16_bf16 v[48:63], v[88:91], v[8:11], v[16:31]
    v_exp_f32 v64, v64
    v_exp_f32 v65, v65
    v_exp_f32 v66, v66
    v_exp_f32 v67, v67
    v_cvt_pk_bf16_f32 v80, v64, v65
    v_exp_f32 v68, v68
    v_exp_f32 v69, v69
    v_cvt_pk_bf16_f32 v81, v66, v67
    v_mfma_f32_32x32x16_bf16 v[32:47], v[100:103], v[84:87], v[32:47]
    ds_read_b128 v[92:95], v13 offset:19456
    s_mov_b64 exec, s[60:61]
    ds_read_b128 v[96:99], v5 offset:22528
    ds_read_b128 v[100:103], v5 offset:23040
    s_mov_b64 exec, -1
    v_exp_f32 v70, v70
    v_exp_f32 v71, v71
    v_cvt_pk_bf16_f32 v82, v68, v69
    v_exp_f32 v72, v72
    v_exp_f32 v73, v73
    v_cvt_pk_bf16_f32 v83, v70, v71
    v_exp_f32 v74, v74
    v_exp_f32 v75, v75
    v_mfma_f32_32x32x16_bf16 v[32:47], v[104:107], v[80:83], v[32:47]
    v_cvt_pk_bf16_f32 v84, v72, v73
    v_exp_f32 v76, v76
    v_exp_f32 v77, v77
    v_cvt_pk_bf16_f32 v85, v74, v75
    v_exp_f32 v78, v78
    v_exp_f32 v79, v79
    v_cvt_pk_bf16_f32 v86, v76, v77
    v_cvt_pk_bf16_f32 v87, v78, v79
    s_waitcnt vmcnt(2)
    s_cbranch_vccz L_w7_31
    s_waitcnt vmcnt(2)
L_w7_31:
    s_waitcnt lgkmcnt(0)
    s_barrier
    s_cbranch_vccz L_w7_32
    s_lshr_b32 s3, s49, 2
    s_lshl_b32 s3, s3, 8
    s_lshl_b32 s4, s93, 3
    s_add_u32 s3, s3, s4
    s_add_u32 s3, s3, 12288
    v_mov_b32 v112, s51
    v_mov_b32 v113, s52
    v_mov_b32 v2, 0
    s_mov_b64 exec, 1
    buffer_store_dwordx2 v[112:113], v2, s[44:47], s3 offen sc1
    s_mov_b64 exec, -1
L_w7_32:
    s_setprio 3
    v_mfma_f32_32x32x16_bf16 v[64:79], v[92:95], v[8:11], v[16:31]
    v_exp_f32 v48, v48
    v_exp_f32 v49, v49
    v_exp_f32 v50, v50
    v_exp_f32 v51, v51
    v_cvt_pk_bf16_f32 v80, v48, v49
    v_exp_f32 v52, v52
    v_exp_f32 v53, v53
    v_cvt_pk_bf16_f32 v81, v50, v51
    v_mfma_f32_32x32x16_bf16 v[32:47], v[108:111], v[84:87], v[32:47]
    ds_read_b128 v[88:91], v13 offset:24576
    s_mov_b64 exec, s[60:61]
    ds_read_b128 v[104:107], v5 offset:23552
    ds_read_b128 v[108:111], v5 offset:24064
    s_mov_b64 exec, -1
    v_exp_f32 v54, v54
    v_exp_f32 v55, v55
    v_cvt_pk_bf16_f32 v82, v52, v53
    v_exp_f32 v56, v56
    v_exp_f32 v57, v57
    v_cvt_pk_bf16_f32 v83, v54, v55
    v_exp_f32 v58, v58
    v_exp_f32 v59, v59
    v_mfma_f32_32x32x16_bf16 v[32:47], v[96:99], v[80:83], v[32:47]
    v_cvt_pk_bf16_f32 v84, v56, v57
    v_exp_f32 v60, v60
    v_exp_f32 v61, v61
    v_cvt_pk_bf16_f32 v85, v58, v59
    v_exp_f32 v62, v62
    v_exp_f32 v63, v63
    v_cvt_pk_bf16_f32 v86, v60, v61
    v_cvt_pk_bf16_f32 v87, v62, v63
    s_waitcnt lgkmcnt(0)
    v_mfma_f32_32x32x16_bf16 v[48:63], v[88:91], v[8:11], v[16:31]
    v_exp_f32 v64, v64
    v_exp_f32 v65, v65
    v_exp_f32 v66, v66
    v_exp_f32 v67, v67
    v_cvt_pk_bf16_f32 v80, v64, v65
    v_exp_f32 v68, v68
    v_exp_f32 v69, v69
    v_cvt_pk_bf16_f32 v81, v66, v67
    v_mfma_f32_32x32x16_bf16 v[32:47], v[100:103], v[84:87], v[32:47]
    ds_read_b128 v[92:95], v13 offset:25600
    s_mov_b64 exec, s[60:61]
    ds_read_b128 v[96:99], v5 offset:28672
    ds_read_b128 v[100:103], v5 offset:29184
    s_mov_b64 exec, -1
    v_exp_f32 v70, v70
    v_exp_f32 v71, v71
    v_cvt_pk_bf16_f32 v82, v68, v69
    s_cbranch_vccnz L_t7_33
    s_add_u32 m0, s96, 2176
    s_mov_b32 s3, 114688
    buffer_load_dwordx4 v6, s[20:23], s3 offen  lds
L_t7_33:
    v_exp_f32 v72, v72
    v_exp_f32 v73, v73
    v_cvt_pk_bf16_f32 v83, v70, v71
    v_exp_f32 v74, v74
    v_exp_f32 v75, v75
    v_mfma_f32_32x32x16_bf16 v[32:47], v[104:107], v[80:83], v[32:47]
    v_cvt_pk_bf16_f32 v84, v72, v73
    v_exp_f32 v76, v76
    v_exp_f32 v77, v77
    v_cvt_pk_bf16_f32 v85, v74, v75
    s_cbranch_vccnz L_t7_35
    s_add_u32 m0, s96, 3328
    s_mov_b32 s3, 114688
    buffer_load_dwordx4 v6, s[24:27], s3 offen  lds
    s_branch L_t7d_36
L_t7_35:
    s_add_u32 s3, s82, 0
    buffer_load_dword v14, v15, s[28:31], s3 offen
L_t7d_36:
    v_exp_f32 v78, v78
    v_exp_f32 v79, v79
    v_cvt_pk_bf16_f32 v86, v76, v77
    v_cvt_pk_bf16_f32 v87, v78, v79
    s_waitcnt lgkmcnt(0)
    v_mfma_f32_32x32x16_bf16 v[64:79], v[92:95], v[8:11], v[16:31]
    v_exp_f32 v48, v48
    v_exp_f32 v49, v49
    v_exp_f32 v50, v50
    v_exp_f32 v51, v51
    v_cvt_pk_bf16_f32 v80, v48, v49
    v_exp_f32 v52, v52
    v_exp_f32 v53, v53
    v_cvt_pk_bf16_f32 v81, v50, v51
    v_mfma_f32_32x32x16_bf16 v[32:47], v[108:111], v[84:87], v[32:47]
    ds_read_b128 v[88:91], v13 offset:26624
    s_mov_b64 exec, s[60:61]
    ds_read_b128 v[104:107], v5 offset:29696
    ds_read_b128 v[108:111], v5 offset:30208
    s_mov_b64 exec, -1
    v_exp_f32 v54, v54
    v_exp_f32 v55, v55
    v_cvt_pk_bf16_f32 v82, v52, v53
    v_exp_f32 v56, v56
    v_exp_f32 v57, v57
    v_cvt_pk_bf16_f32 v83, v54, v55
    v_exp_f32 v58, v58
    v_exp_f32 v59, v59
    v_mfma_f32_32x32x16_bf16 v[32:47], v[96:99], v[80:83], v[32:47]
    v_cvt_pk_bf16_f32 v84, v56, v57
    v_exp_f32 v60, v60
    v_exp_f32 v61, v61
    v_cvt_pk_bf16_f32 v85, v58, v59
    v_exp_f32 v62, v62
    v_exp_f32 v63, v63
    v_cvt_pk_bf16_f32 v86, v60, v61
    v_cvt_pk_bf16_f32 v87, v62, v63
    s_waitcnt lgkmcnt(0)
    v_mfma_f32_32x32x16_bf16 v[48:63], v[88:91], v[8:11], v[16:31]
    v_exp_f32 v64, v64
    v_exp_f32 v65, v65
    v_exp_f32 v66, v66
    v_exp_f32 v67, v67
    v_cvt_pk_bf16_f32 v80, v64, v65
    s_waitcnt vmcnt(2)
    ds_read_b64_tr_b16 v[128:129], v116 offset:0
    ds_read_b64_tr_b16 v[130:131], v116 offset:128
    v_exp_f32 v68, v68
    v_exp_f32 v69, v69
    v_cvt_pk_bf16_f32 v81, v66, v67
    v_mfma_f32_32x32x16_bf16 v[32:47], v[100:103], v[84:87], v[32:47]
    ds_read_b128 v[92:95], v13 offset:27648
    s_mov_b64 exec, s[60:61]
    ds_read_b128 v[96:99], v5 offset:30720
    ds_read_b128 v[100:103], v5 offset:31232
    s_mov_b64 exec, -1
    v_exp_f32 v70, v70
    v_exp_f32 v71, v71
    v_cvt_pk_bf16_f32 v82, v68, v69
    v_exp_f32 v72, v72
    v_exp_f32 v73, v73
    v_cvt_pk_bf16_f32 v83, v70, v71
    ds_read_b64_tr_b16 v[132:133], v116 offset:512
    ds_read_b64_tr_b16 v[134:135], v116 offset:640
    v_exp_f32 v74, v74
    v_exp_f32 v75, v75
    v_mfma_f32_32x32x16_bf16 v[32:47], v[104:107], v[80:83], v[32:47]
    v_cvt_pk_bf16_f32 v84, v72, v73
    v_exp_f32 v76, v76
    v_exp_f32 v77, v77
    v_cvt_pk_bf16_f32 v85, v74, v75
    v_exp_f32 v78, v78
    v_exp_f32 v79, v79
    v_cvt_pk_bf16_f32 v86, v76, v77
    v_cvt_pk_bf16_f32 v87, v78, v79
    s_waitcnt lgkmcnt(0)
    v_mfma_f32_32x32x16_bf16 v[64:79], v[92:95], v[8:11], v[16:31]
    v_exp_f32 v48, v48
    v_exp_f32 v49, v49
    v_exp_f32 v50, v50
    v_exp_f32 v51, v51
    v_cvt_pk_bf16_f32 v80, v48, v49
    v_exp_f32 v52, v52
    v_exp_f32 v53, v53
    v_cvt_pk_bf16_f32 v81, v50, v51
    v_mfma_f32_32x32x16_bf16 v[32:47], v[108:111], v[84:87], v[32:47]
    ds_read_b128 v[88:91], v13 offset:32768
    s_mov_b64 exec, s[60:61]
    ds_read_b128 v[104:107], v5 offset:31744
    ds_read_b128 v[108:111], v5 offset:32256
    s_mov_b64 exec, -1
    v_exp_f32 v54, v54
    v_exp_f32 v55, v55
    v_cvt_pk_bf16_f32 v82, v52, v53
    s_cbranch_vccnz L_t7_37
    s_add_u32 m0, s96, 0
    s_mov_b32 s3, 229376
    buffer_load_dwordx4 v6, s[20:23], s3 offen  lds
L_t7_37:
    v_exp_f32 v56, v56
    v_exp_f32 v57, v57
    v_cvt_pk_bf16_f32 v83, v54, v55
    v_exp_f32 v58, v58
    v_exp_f32 v59, v59
    v_mfma_f32_32x32x16_bf16 v[32:47], v[96:99], v[80:83], v[32:47]
    v_cvt_pk_bf16_f32 v84, v56, v57
    v_exp_f32 v60, v60
    v_exp_f32 v61, v61
    v_cvt_pk_bf16_f32 v85, v58, v59
    s_cbranch_vccnz L_t7_39
    s_add_u32 m0, s96, 1152
    s_mov_b32 s3, 229376
    buffer_load_dwordx4 v6, s[24:27], s3 offen  lds
L_t7_39:
    v_exp_f32 v62, v62
    v_exp_f32 v63, v63
    v_cvt_pk_bf16_f32 v86, v60, v61
    v_cvt_pk_bf16_f32 v87, v62, v63
    s_waitcnt lgkmcnt(0)
    v_mfma_f32_32x32x16_bf16 v[48:63], v[88:91], v[8:11], v[16:31]
    v_exp_f32 v64, v64
    v_exp_f32 v65, v65
    v_exp_f32 v66, v66
    v_exp_f32 v67, v67
    v_cvt_pk_bf16_f32 v80, v64, v65
    v_exp_f32 v68, v68
    v_exp_f32 v69, v69
    v_cvt_pk_bf16_f32 v81, v66, v67
    v_mfma_f32_32x32x16_bf16 v[32:47], v[100:103], v[84:87], v[32:47]
    ds_read_b128 v[92:95], v13 offset:33792
    s_mov_b64 exec, s[60:61]
    ds_read_b128 v[96:99], v5 offset:36864
    ds_read_b128 v[100:103], v5 offset:37376
    s_mov_b64 exec, -1
    v_exp_f32 v70, v70
    v_exp_f32 v71, v71
    v_cvt_pk_bf16_f32 v82, v68, v69
    v_exp_f32 v72, v72
    v_exp_f32 v73, v73
    v_cvt_pk_bf16_f32 v83, v70, v71
    v_exp_f32 v74, v74
    v_exp_f32 v75, v75
    v_mfma_f32_32x32x16_bf16 v[32:47], v[104:107], v[80:83], v[32:47]
    v_cvt_pk_bf16_f32 v84, v72, v73
    v_exp_f32 v76, v76
    v_exp_f32 v77, v77
    v_cvt_pk_bf16_f32 v85, v74, v75
    v_exp_f32 v78, v78
    v_exp_f32 v79, v79
    v_cvt_pk_bf16_f32 v86, v76, v77
    v_cvt_pk_bf16_f32 v87, v78, v79
    s_waitcnt lgkmcnt(0)
    v_mfma_f32_32x32x16_bf16 v[64:79], v[92:95], v[8:11], v[16:31]
    v_exp_f32 v48, v48
    v_exp_f32 v49, v49
    v_exp_f32 v50, v50
    v_exp_f32 v51, v51
    v_cvt_pk_bf16_f32 v80, v48, v49
    s_waitcnt vmcnt(2)
    ds_read_b64_tr_b16 v[136:137], v116 offset:2176
    ds_read_b64_tr_b16 v[138:139], v116 offset:2304
    v_exp_f32 v52, v52
    v_exp_f32 v53, v53
    v_cvt_pk_bf16_f32 v81, v50, v51
    v_mfma_f32_32x32x16_bf16 v[32:47], v[108:111], v[84:87], v[32:47]
    ds_read_b128 v[88:91], v13 offset:34816
    s_mov_b64 exec, s[60:61]
    ds_read_b128 v[104:107], v5 offset:37888
    ds_read_b128 v[108:111], v5 offset:38400
    s_mov_b64 exec, -1
    v_exp_f32 v54, v54
    v_exp_f32 v55, v55
    v_cvt_pk_bf16_f32 v82, v52, v53
    v_exp_f32 v56, v56
    v_exp_f32 v57, v57
    v_cvt_pk_bf16_f32 v83, v54, v55
    ds_read_b64_tr_b16 v[140:141], v116 offset:2688
    ds_read_b64_tr_b16 v[142:143], v116 offset:2816
    v_exp_f32 v58, v58
    v_exp_f32 v59, v59
    v_mfma_f32_32x32x16_bf16 v[32:47], v[96:99], v[80:83], v[32:47]
    v_cvt_pk_bf16_f32 v84, v56, v57
    v_exp_f32 v60, v60
    v_exp_f32 v61, v61
    v_cvt_pk_bf16_f32 v85, v58, v59
    v_exp_f32 v62, v62
    v_exp_f32 v63, v63
    v_cvt_pk_bf16_f32 v86, v60, v61
    v_cvt_pk_bf16_f32 v87, v62, v63
    s_waitcnt lgkmcnt(0)
    v_mfma_f32_32x32x16_bf16 v[48:63], v[88:91], v[8:11], v[16:31]
    v_exp_f32 v64, v64
    v_exp_f32 v65, v65
    v_exp_f32 v66, v66
    v_exp_f32 v67, v67
    v_cvt_pk_bf16_f32 v80, v64, v65
    v_exp_f32 v68, v68
    v_exp_f32 v69, v69
    v_cvt_pk_bf16_f32 v81, v66, v67
    v_mfma_f32_32x32x16_bf16 v[32:47], v[100:103], v[84:87], v[32:47]
    ds_read_b128 v[92:95], v13 offset:35840
    s_mov_b64 exec, s[60:61]
    ds_read_b128 v[96:99], v5 offset:38912
    ds_read_b128 v[100:103], v5 offset:39424
    s_mov_b64 exec, -1
    v_exp_f32 v70, v70
    v_exp_f32 v71, v71
    v_cvt_pk_bf16_f32 v82, v68, v69
    s_cbranch_vccnz L_t7_41
    s_add_u32 m0, s96, 2176
    s_mov_b32 s3, 344064
    buffer_load_dwordx4 v6, s[20:23], s3 offen  lds
    s_branch L_t7d_42
L_t7_41:
    s_add_u32 s3, s82, 8192
    buffer_load_dword v14, v15, s[28:31], s3 offen
L_t7d_42:
    v_exp_f32 v72, v72
    v_exp_f32 v73, v73
    v_cvt_pk_bf16_f32 v83, v70, v71
    v_exp_f32 v74, v74
    v_exp_f32 v75, v75
    v_mfma_f32_32x32x16_bf16 v[32:47], v[104:107], v[80:83], v[32:47]
    v_cvt_pk_bf16_f32 v84, v72, v73
    v_exp_f32 v76, v76
    v_exp_f32 v77, v77
    v_cvt_pk_bf16_f32 v85, v74, v75
    s_cbranch_vccnz L_t7_43
    s_add_u32 m0, s96, 3328
    s_mov_b32 s3, 344064
    buffer_load_dwordx4 v6, s[24:27], s3 offen  lds
L_t7_43:
    v_exp_f32 v78, v78
    v_exp_f32 v79, v79
    v_cvt_pk_bf16_f32 v86, v76, v77
    v_cvt_pk_bf16_f32 v87, v78, v79
    s_waitcnt lgkmcnt(0)
    v_mfma_f32_32x32x16_bf16 v[64:79], v[92:95], v[8:11], v[16:31]
    v_exp_f32 v48, v48
    v_exp_f32 v49, v49
    v_exp_f32 v50, v50
    v_exp_f32 v51, v51
    v_cvt_pk_bf16_f32 v80, v48, v49
    v_exp_f32 v52, v52
    v_exp_f32 v53, v53
    v_cvt_pk_bf16_f32 v81, v50, v51
    v_mfma_f32_32x32x16_bf16 v[32:47], v[108:111], v[84:87], v[32:47]
    ds_read_b128 v[88:91], v13 offset:40960
    s_mov_b64 exec, s[60:61]
    ds_read_b128 v[104:107], v5 offset:39936
    ds_read_b128 v[108:111], v5 offset:40448
    s_mov_b64 exec, -1
    v_exp_f32 v54, v54
    v_exp_f32 v55, v55
    v_cvt_pk_bf16_f32 v82, v52, v53
    v_exp_f32 v56, v56
    v_exp_f32 v57, v57
    v_cvt_pk_bf16_f32 v83, v54, v55
    v_exp_f32 v58, v58
    v_exp_f32 v59, v59
    v_mfma_f32_32x32x16_bf16 v[32:47], v[96:99], v[80:83], v[32:47]
    v_cvt_pk_bf16_f32 v84, v56, v57
    v_exp_f32 v60, v60
    v_exp_f32 v61, v61
    v_cvt_pk_bf16_f32 v85, v58, v59
    v_exp_f32 v62, v62
    v_exp_f32 v63, v63
    v_cvt_pk_bf16_f32 v86, v60, v61
    v_cvt_pk_bf16_f32 v87, v62, v63
    s_waitcnt lgkmcnt(0)
    v_mfma_f32_32x32x16_bf16 v[48:63], v[88:91], v[8:11], v[16:31]
    v_exp_f32 v64, v64
    v_exp_f32 v65, v65
    v_exp_f32 v66, v66
    v_exp_f32 v67, v67
    v_cvt_pk_bf16_f32 v80, v64, v65
    s_waitcnt vmcnt(2)
    ds_read_b64_tr_b16 v[144:145], v116 offset:0
    ds_read_b64_tr_b16 v[146:147], v116 offset:128
    v_exp_f32 v68, v68
    v_exp_f32 v69, v69
    v_cvt_pk_bf16_f32 v81, v66, v67
    v_mfma_f32_32x32x16_bf16 v[32:47], v[100:103], v[84:87], v[32:47]
    ds_read_b128 v[92:95], v13 offset:41984
    s_mov_b64 exec, s[60:61]
    ds_read_b128 v[96:99], v5 offset:45056
    ds_read_b128 v[100:103], v5 offset:45568
    s_mov_b64 exec, -1
    v_exp_f32 v70, v70
    v_exp_f32 v71, v71
    v_cvt_pk_bf16_f32 v82, v68, v69
    v_exp_f32 v72, v72
    v_exp_f32 v73, v73
    v_cvt_pk_bf16_f32 v83, v70, v71
    ds_read_b64_tr_b16 v[148:149], v116 offset:512
    ds_read_b64_tr_b16 v[150:151], v116 offset:640
    v_exp_f32 v74, v74
    v_exp_f32 v75, v75
    v_mfma_f32_32x32x16_bf16 v[32:47], v[104:107], v[80:83], v[32:47]
    v_cvt_pk_bf16_f32 v84, v72, v73
    v_exp_f32 v76, v76
    v_exp_f32 v77, v77
    v_cvt_pk_bf16_f32 v85, v74, v75
    v_exp_f32 v78, v78
    v_exp_f32 v79, v79
    v_cvt_pk_bf16_f32 v86, v76, v77
    v_cvt_pk_bf16_f32 v87, v78, v79
    s_waitcnt lgkmcnt(0)
    v_mfma_f32_32x32x16_bf16 v[64:79], v[92:95], v[8:11], v[16:31]
    v_exp_f32 v48, v48
    v_exp_f32 v49, v49
    v_exp_f32 v50, v50
    v_exp_f32 v51, v51
    v_cvt_pk_bf16_f32 v80, v48, v49
    v_exp_f32 v52, v52
    v_exp_f32 v53, v53
    v_cvt_pk_bf16_f32 v81, v50, v51
    v_mfma_f32_32x32x16_bf16 v[32:47], v[108:111], v[84:87], v[32:47]
    ds_read_b128 v[88:91], v13 offset:43008
    s_mov_b64 exec, s[60:61]
    ds_read_b128 v[104:107], v5 offset:46080
    ds_read_b128 v[108:111], v5 offset:46592
    s_mov_b64 exec, -1
    v_exp_f32 v54, v54
    v_exp_f32 v55, v55
    v_cvt_pk_bf16_f32 v82, v52, v53
    s_cbranch_vccnz L_t7_45
    s_add_u32 m0, s96, 0
    s_mov_b32 s3, 458752
    buffer_load_dwordx4 v6, s[20:23], s3 offen  lds
L_t7_45:
    v_exp_f32 v56, v56
    v_exp_f32 v57, v57
    v_cvt_pk_bf16_f32 v83, v54, v55
    v_exp_f32 v58, v58
    v_exp_f32 v59, v59
    v_mfma_f32_32x32x16_bf16 v[32:47], v[96:99], v[80:83], v[32:47]
    v_cvt_pk_bf16_f32 v84, v56, v57
    v_exp_f32 v60, v60
    v_exp_f32 v61, v61
    v_cvt_pk_bf16_f32 v85, v58, v59
    s_cbranch_vccnz L_t7_47
    s_add_u32 m0, s96, 1152
    s_mov_b32 s3, 458752
    buffer_load_dwordx4 v6, s[24:27], s3 offen  lds
    s_branch L_t7d_48
L_t7_47:
    s_add_u32 s3, s82, 16384
    buffer_load_dword v14, v15, s[28:31], s3 offen
L_t7d_48:
    v_exp_f32 v62, v62
    v_exp_f32 v63, v63
    v_cvt_pk_bf16_f32 v86, v60, v61
    v_cvt_pk_bf16_f32 v87, v62, v63
    s_waitcnt lgkmcnt(0)
    v_mfma_f32_32x32x16_bf16 v[48:63], v[88:91], v[8:11], v[16:31]
    v_exp_f32 v64, v64
    v_exp_f32 v65, v65
    v_exp_f32 v66, v66
    v_exp_f32 v67, v67
    v_cvt_pk_bf16_f32 v80, v64, v65
    v_exp_f32 v68, v68
    v_exp_f32 v69, v69
    v_cvt_pk_bf16_f32 v81, v66, v67
    v_mfma_f32_32x32x16_bf16 v[32:47], v[100:103], v[84:87], v[32:47]
    ds_read_b128 v[92:95], v13 offset:44032
    s_mov_b64 exec, s[60:61]
    ds_read_b128 v[96:99], v5 offset:47104
    ds_read_b128 v[100:103], v5 offset:47616
    s_mov_b64 exec, -1
    v_exp_f32 v70, v70
    v_exp_f32 v71, v71
    v_cvt_pk_bf16_f32 v82, v68, v69
    v_exp_f32 v72, v72
    v_exp_f32 v73, v73
    v_cvt_pk_bf16_f32 v83, v70, v71
    v_exp_f32 v74, v74
    v_exp_f32 v75, v75
    v_mfma_f32_32x32x16_bf16 v[32:47], v[104:107], v[80:83], v[32:47]
    v_cvt_pk_bf16_f32 v84, v72, v73
    v_exp_f32 v76, v76
    v_exp_f32 v77, v77
    v_cvt_pk_bf16_f32 v85, v74, v75
    v_exp_f32 v78, v78
    v_exp_f32 v79, v79
    v_cvt_pk_bf16_f32 v86, v76, v77
    v_cvt_pk_bf16_f32 v87, v78, v79
    s_waitcnt lgkmcnt(0)
    v_mfma_f32_32x32x16_bf16 v[64:79], v[92:95], v[8:11], v[16:31]
    v_exp_f32 v48, v48
    v_exp_f32 v49, v49
    v_exp_f32 v50, v50
    v_exp_f32 v51, v51
    v_cvt_pk_bf16_f32 v80, v48, v49
    s_waitcnt vmcnt(2)
    ds_read_b64_tr_b16 v[152:153], v116 offset:2176
    ds_read_b64_tr_b16 v[154:155], v116 offset:2304
    v_exp_f32 v52, v52
    v_exp_f32 v53, v53
    v_cvt_pk_bf16_f32 v81, v50, v51
    v_mfma_f32_32x32x16_bf16 v[32:47], v[108:111], v[84:87], v[32:47]
    ds_read_b128 v[88:91], v13 offset:49152
    s_mov_b64 exec, s[60:61]
    ds_read_b128 v[104:107], v5 offset:48128
    ds_read_b128 v[108:111], v5 offset:48640
    s_mov_b64 exec, -1
    v_exp_f32 v54, v54
    v_exp_f32 v55, v55
    v_cvt_pk_bf16_f32 v82, v52, v53
    v_exp_f32 v56, v56
    v_exp_f32 v57, v57
    v_cvt_pk_bf16_f32 v83, v54, v55
    ds_read_b64_tr_b16 v[156:157], v116 offset:2688
    ds_read_b64_tr_b16 v[158:159], v116 offset:2816
    v_exp_f32 v58, v58
    v_exp_f32 v59, v59
    v_mfma_f32_32x32x16_bf16 v[32:47], v[96:99], v[80:83], v[32:47]
    v_cvt_pk_bf16_f32 v84, v56, v57
    v_exp_f32 v60, v60
    v_exp_f32 v61, v61
    v_cvt_pk_bf16_f32 v85, v58, v59
    v_exp_f32 v62, v62
    v_exp_f32 v63, v63
    v_cvt_pk_bf16_f32 v86, v60, v61
    v_cvt_pk_bf16_f32 v87, v62, v63
    s_waitcnt lgkmcnt(0)
    v_mfma_f32_32x32x16_bf16 v[48:63], v[88:91], v[8:11], v[16:31]
    v_exp_f32 v64, v64
    v_exp_f32 v65, v65
    v_exp_f32 v66, v66
    v_exp_f32 v67, v67
    v_cvt_pk_bf16_f32 v80, v64, v65
    v_exp_f32 v68, v68
    v_exp_f32 v69, v69
    v_cvt_pk_bf16_f32 v81, v66, v67
    v_mfma_f32_32x32x16_bf16 v[32:47], v[100:103], v[84:87], v[32:47]
    ds_read_b128 v[92:95], v13 offset:50176
    s_mov_b64 exec, s[60:61]
    ds_read_b128 v[96:99], v5 offset:53248
    ds_read_b128 v[100:103], v5 offset:53760
    s_mov_b64 exec, -1
    v_exp_f32 v70, v70
    v_exp_f32 v71, v71
    v_cvt_pk_bf16_f32 v82, v68, v69
    s_cbranch_vccnz L_t7_49
    s_add_u32 m0, s96, 2176
    s_mov_b32 s3, 573440
    buffer_load_dwordx4 v6, s[20:23], s3 offen  lds
L_t7_49:
    v_exp_f32 v72, v72
    v_exp_f32 v73, v73
    v_cvt_pk_bf16_f32 v83, v70, v71
    v_exp_f32 v74, v74
    v_exp_f32 v75, v75
    v_mfma_f32_32x32x16_bf16 v[32:47], v[104:107], v[80:83], v[32:47]
    v_cvt_pk_bf16_f32 v84, v72, v73
    v_exp_f32 v76, v76
    v_exp_f32 v77, v77
    v_cvt_pk_bf16_f32 v85, v74, v75
    s_cbranch_vccnz L_t7_51
    s_add_u32 m0, s96, 3328
    s_mov_b32 s3, 573440
    buffer_load_dwordx4 v6, s[24:27], s3 offen  lds
L_t7_51:
    v_exp_f32 v78, v78
    v_exp_f32 v79, v79
    v_cvt_pk_bf16_f32 v86, v76, v77
    v_cvt_pk_bf16_f32 v87, v78, v79
    s_waitcnt lgkmcnt(0)
    v_mfma_f32_32x32x16_bf16 v[64:79], v[92:95], v[8:11], v[16:31]
    v_exp_f32 v48, v48
    v_exp_f32 v49, v49
    v_exp_f32 v50, v50
    v_exp_f32 v51, v51
    v_cvt_pk_bf16_f32 v80, v48, v49
    v_exp_f32 v52, v52
    v_exp_f32 v53, v53
    v_cvt_pk_bf16_f32 v81, v50, v51
    v_mfma_f32_32x32x16_bf16 v[32:47], v[108:111], v[84:87], v[32:47]
    ds_read_b128 v[88:91], v13 offset:51200
    s_mov_b64 exec, s[60:61]
    ds_read_b128 v[104:107], v5 offset:54272
    ds_read_b128 v[108:111], v5 offset:54784
    s_mov_b64 exec, -1
    v_exp_f32 v54, v54
    v_exp_f32 v55, v55
    v_cvt_pk_bf16_f32 v82, v52, v53
    v_exp_f32 v56, v56
    v_exp_f32 v57, v57
    v_cvt_pk_bf16_f32 v83, v54, v55
    v_exp_f32 v58, v58
    v_exp_f32 v59, v59
    v_mfma_f32_32x32x16_bf16 v[32:47], v[96:99], v[80:83], v[32:47]
    v_cvt_pk_bf16_f32 v84, v56, v57
    v_exp_f32 v60, v60
    v_exp_f32 v61, v61
    v_cvt_pk_bf16_f32 v85, v58, v59
    v_exp_f32 v62, v62
    v_exp_f32 v63, v63
    v_cvt_pk_bf16_f32 v86, v60, v61
    v_cvt_pk_bf16_f32 v87, v62, v63
    s_waitcnt lgkmcnt(0)
    v_mfma_f32_32x32x16_bf16 v[48:63], v[88:91], v[8:11], v[16:31]
    v_exp_f32 v64, v64
    v_exp_f32 v65, v65
    v_exp_f32 v66, v66
    v_exp_f32 v67, v67
    v_cvt_pk_bf16_f32 v80, v64, v65
    s_waitcnt vmcnt(2)
    ds_read_b64_tr_b16 v[160:161], v116 offset:0
    ds_read_b64_tr_b16 v[162:163], v116 offset:128
    v_exp_f32 v68, v68
    v_exp_f32 v69, v69
    v_cvt_pk_bf16_f32 v81, v66, v67
    v_mfma_f32_32x32x16_bf16 v[32:47], v[100:103], v[84:87], v[32:47]
    ds_read_b128 v[92:95], v13 offset:52224
    s_mov_b64 exec, s[60:61]
    ds_read_b128 v[96:99], v5 offset:55296
    ds_read_b128 v[100:103], v5 offset:55808
    s_mov_b64 exec, -1
    v_exp_f32 v70, v70
    v_exp_f32 v71, v71
    v_cvt_pk_bf16_f32 v82, v68, v69
    v_exp_f32 v72, v72
    v_exp_f32 v73, v73
    v_cvt_pk_bf16_f32 v83, v70, v71
    ds_read_b64_tr_b16 v[164:165], v116 offset:512
    ds_read_b64_tr_b16 v[166:167], v116 offset:640
    v_exp_f32 v74, v74
    v_exp_f32 v75, v75
    v_mfma_f32_32x32x16_bf16 v[32:47], v[104:107], v[80:83], v[32:47]
    v_cvt_pk_bf16_f32 v84, v72, v73
    v_exp_f32 v76, v76
    v_exp_f32 v77, v77
    v_cvt_pk_bf16_f32 v85, v74, v75
    v_exp_f32 v78, v78
    v_exp_f32 v79, v79
    v_cvt_pk_bf16_f32 v86, v76, v77
    v_cvt_pk_bf16_f32 v87, v78, v79
    s_waitcnt lgkmcnt(0)
    v_mfma_f32_32x32x16_bf16 v[64:79], v[92:95], v[8:11], v[16:31]
    v_exp_f32 v48, v48
    v_exp_f32 v49, v49
    v_exp_f32 v50, v50
    v_exp_f32 v51, v51
    v_cvt_pk_bf16_f32 v80, v48, v49
    v_exp_f32 v52, v52
    v_exp_f32 v53, v53
    v_cvt_pk_bf16_f32 v81, v50, v51
    v_mfma_f32_32x32x16_bf16 v[32:47], v[108:111], v[84:87], v[32:47]
    ds_read_b128 v[88:91], v13 offset:57344
    s_mov_b64 exec, s[60:61]
    ds_read_b128 v[104:107], v5 offset:56320
    ds_read_b128 v[108:111], v5 offset:56832
    s_mov_b64 exec, -1
    v_exp_f32 v54, v54
    v_exp_f32 v55, v55
    v_cvt_pk_bf16_f32 v82, v52, v53
    s_cbranch_vccnz L_t7_53
    s_add_u32 m0, s96, 0
    s_mov_b32 s3, 688128
    buffer_load_dwordx4 v6, s[20:23], s3 offen  lds
    s_branch L_t7d_54
L_t7_53:
    s_add_u32 s3, s82, 24576
    buffer_load_dword v14, v15, s[28:31], s3 offen
L_t7d_54:
    v_exp_f32 v56, v56
    v_exp_f32 v57, v57
    v_cvt_pk_bf16_f32 v83, v54, v55
    v_exp_f32 v58, v58
    v_exp_f32 v59, v59
    v_mfma_f32_32x32x16_bf16 v[32:47], v[96:99], v[80:83], v[32:47]
    v_cvt_pk_bf16_f32 v84, v56, v57
    v_exp_f32 v60, v60
    v_exp_f32 v61, v61
    v_cvt_pk_bf16_f32 v85, v58, v59
    s_cbranch_vccnz L_t7_55
    s_add_u32 m0, s96, 1152
    s_mov_b32 s3, 688128
    buffer_load_dwordx4 v6, s[24:27], s3 offen  lds
L_t7_55:
    v_exp_f32 v62, v62
    v_exp_f32 v63, v63
    v_cvt_pk_bf16_f32 v86, v60, v61
    v_cvt_pk_bf16_f32 v87, v62, v63
    s_waitcnt lgkmcnt(0)
    v_mfma_f32_32x32x16_bf16 v[48:63], v[88:91], v[8:11], v[16:31]
    v_exp_f32 v64, v64
    v_exp_f32 v65, v65
    v_exp_f32 v66, v66
    v_exp_f32 v67, v67
    v_cvt_pk_bf16_f32 v80, v64, v65
    v_exp_f32 v68, v68
    v_exp_f32 v69, v69
    v_cvt_pk_bf16_f32 v81, v66, v67
    v_mfma_f32_32x32x16_bf16 v[32:47], v[100:103], v[84:87], v[32:47]
    ds_read_b128 v[92:95], v13 offset:58368
    s_mov_b64 exec, s[60:61]
    ds_read_b128 v[96:99], v5 offset:61440
    ds_read_b128 v[100:103], v5 offset:61952
    s_mov_b64 exec, -1
    v_exp_f32 v70, v70
    v_exp_f32 v71, v71
    v_cvt_pk_bf16_f32 v82, v68, v69
    v_exp_f32 v72, v72
    v_exp_f32 v73, v73
    v_cvt_pk_bf16_f32 v83, v70, v71
    v_exp_f32 v74, v74
    v_exp_f32 v75, v75
    v_mfma_f32_32x32x16_bf16 v[32:47], v[104:107], v[80:83], v[32:47]
    v_cvt_pk_bf16_f32 v84, v72, v73
    v_exp_f32 v76, v76
    v_exp_f32 v77, v77
    v_cvt_pk_bf16_f32 v85, v74, v75
    v_exp_f32 v78, v78
    v_exp_f32 v79, v79
    v_cvt_pk_bf16_f32 v86, v76, v77
    v_cvt_pk_bf16_f32 v87, v78, v79
    s_waitcnt lgkmcnt(0)
    s_setprio 2
    v_mfma_f32_32x32x16_bf16 v[64:79], v[92:95], v[8:11], v[16:31]
    v_exp_f32 v48, v48
    v_exp_f32 v49, v49
    v_exp_f32 v50, v50
    v_exp_f32 v51, v51
    v_cvt_pk_bf16_f32 v80, v48, v49
    s_waitcnt vmcnt(2)
    ds_read_b64_tr_b16 v[168:169], v116 offset:2176
    ds_read_b64_tr_b16 v[170:171], v116 offset:2304
    v_exp_f32 v52, v52
    v_exp_f32 v53, v53
    v_cvt_pk_bf16_f32 v81, v50, v51
    v_mfma_f32_32x32x16_bf16 v[32:47], v[108:111], v[84:87], v[32:47]
    ds_read_b128 v[88:91], v13 offset:59392
    s_mov_b64 exec, s[60:61]
    ds_read_b128 v[104:107], v5 offset:62464
    ds_read_b128 v[108:111], v5 offset:62976
    s_mov_b64 exec, -1
    v_exp_f32 v54, v54
    v_exp_f32 v55, v55
    v_cvt_pk_bf16_f32 v82, v52, v53
    v_exp_f32 v56, v56
    v_exp_f32 v57, v57
    v_cvt_pk_bf16_f32 v83, v54, v55
    ds_read_b64_tr_b16 v[172:173], v116 offset:2688
    ds_read_b64_tr_b16 v[174:175], v116 offset:2816
    v_exp_f32 v58, v58
    v_exp_f32 v59, v59
    v_mfma_f32_32x32x16_bf16 v[32:47], v[96:99], v[80:83], v[32:47]
    v_cvt_pk_bf16_f32 v84, v56, v57
    v_exp_f32 v60, v60
    v_exp_f32 v61, v61
    v_cvt_pk_bf16_f32 v85, v58, v59
    v_exp_f32 v62, v62
    v_exp_f32 v63, v63
    v_cvt_pk_bf16_f32 v86, v60, v61
    v_cvt_pk_bf16_f32 v87, v62, v63
    s_waitcnt lgkmcnt(0)
    v_mfma_f32_32x32x16_bf16 v[48:63], v[88:91], v[8:11], v[16:31]
    v_exp_f32 v64, v64
    v_exp_f32 v65, v65
    v_exp_f32 v66, v66
    v_exp_f32 v67, v67
    v_cvt_pk_bf16_f32 v80, v64, v65
    v_exp_f32 v68, v68
    v_exp_f32 v69, v69
    v_cvt_pk_bf16_f32 v81, v66, v67
    v_mfma_f32_32x32x16_bf16 v[32:47], v[100:103], v[84:87], v[32:47]
    ds_read_b128 v[92:95], v13 offset:60416
    s_mov_b64 exec, s[60:61]
    ds_read_b128 v[96:99], v5 offset:63488
    ds_read_b128 v[100:103], v5 offset:64000
    s_mov_b64 exec, -1
    v_exp_f32 v70, v70
    v_exp_f32 v71, v71
    v_cvt_pk_bf16_f32 v82, v68, v69
    s_cbranch_vccnz L_t7_57
    s_add_u32 m0, s96, 2176
    s_mov_b32 s3, 802816
    buffer_load_dwordx4 v6, s[20:23], s3 offen  lds
L_t7_57:
    v_exp_f32 v72, v72
    v_exp_f32 v73, v73
    v_cvt_pk_bf16_f32 v83, v70, v71
    v_exp_f32 v74, v74
    v_exp_f32 v75, v75
    v_mfma_f32_32x32x16_bf16 v[32:47], v[104:107], v[80:83], v[32:47]
    v_cvt_pk_bf16_f32 v84, v72, v73
    v_exp_f32 v76, v76
    v_exp_f32 v77, v77
    v_cvt_pk_bf16_f32 v85, v74, v75
    s_cbranch_vccnz L_t7_59
    s_add_u32 m0, s96, 3328
    s_mov_b32 s3, 802816
    buffer_load_dwordx4 v6, s[24:27], s3 offen  lds
    s_branch L_t7d_60
L_t7_59:
    s_add_u32 s3, s82, 32768
    buffer_load_dword v14, v15, s[28:31], s3 offen
L_t7d_60:
    v_exp_f32 v78, v78
    v_exp_f32 v79, v79
    v_cvt_pk_bf16_f32 v86, v76, v77
    v_cvt_pk_bf16_f32 v87, v78, v79
    s_waitcnt lgkmcnt(0)
    v_mfma_f32_32x32x16_bf16 v[64:79], v[92:95], v[8:11], v[16:31]
    v_exp_f32 v48, v48
    v_exp_f32 v49, v49
    v_exp_f32 v50, v50
    v_exp_f32 v51, v51
    v_cvt_pk_bf16_f32 v80, v48, v49
    v_exp_f32 v52, v52
    v_exp_f32 v53, v53
    v_cvt_pk_bf16_f32 v81, v50, v51
    v_mfma_f32_32x32x16_bf16 v[32:47], v[108:111], v[84:87], v[32:47]
    v_add_u32 v13, 65536, v13
    ds_read_b128 v[88:91], v13 offset:0
    s_mov_b64 exec, s[60:61]
    ds_read_b128 v[104:107], v5 offset:64512
    ds_read_b128 v[108:111], v5 offset:65024
    s_mov_b64 exec, -1
    v_exp_f32 v54, v54
    v_exp_f32 v55, v55
    v_cvt_pk_bf16_f32 v82, v52, v53
    v_exp_f32 v56, v56
    v_exp_f32 v57, v57
    v_cvt_pk_bf16_f32 v83, v54, v55
    v_exp_f32 v58, v58
    v_exp_f32 v59, v59
    v_mfma_f32_32x32x16_bf16 v[32:47], v[96:99], v[80:83], v[32:47]
    v_cvt_pk_bf16_f32 v84, v56, v57
    v_exp_f32 v60, v60
    v_exp_f32 v61, v61
    v_cvt_pk_bf16_f32 v85, v58, v59
    v_exp_f32 v62, v62
    v_exp_f32 v63, v63
    v_cvt_pk_bf16_f32 v86, v60, v61
    v_cvt_pk_bf16_f32 v87, v62, v63
    s_waitcnt lgkmcnt(0)
    v_mfma_f32_32x32x16_bf16 v[48:63], v[88:91], v[8:11], v[16:31]
    v_exp_f32 v64, v64
    v_exp_f32 v65, v65
    v_exp_f32 v66, v66
    v_exp_f32 v67, v67
    v_cvt_pk_bf16_f32 v80, v64, v65
    s_waitcnt vmcnt(2)
    ds_read_b64_tr_b16 v[176:177], v116 offset:0
    ds_read_b64_tr_b16 v[178:179], v116 offset:128
    v_exp_f32 v68, v68
    v_exp_f32 v69, v69
    v_cvt_pk_bf16_f32 v81, v66, v67
    v_mfma_f32_32x32x16_bf16 v[32:47], v[100:103], v[84:87], v[32:47]
    ds_read_b128 v[92:95], v13 offset:1024
    v_add_u32 v5, 65536, v5
    s_mov_b64 exec, s[60:61]
    ds_read_b128 v[96:99], v5 offset:4096
    ds_read_b128 v[100:103], v5 offset:4608
    s_mov_b64 exec, -1
    v_exp_f32 v70, v70
    v_exp_f32 v71, v71
    v_cvt_pk_bf16_f32 v82, v68, v69
    v_exp_f32 v72, v72
    v_exp_f32 v73, v73
    v_cvt_pk_bf16_f32 v83, v70, v71
    ds_read_b64_tr_b16 v[180:181], v116 offset:512
    ds_read_b64_tr_b16 v[182:183], v116 offset:640
    v_exp_f32 v74, v74
    v_exp_f32 v75, v75
    v_mfma_f32_32x32x16_bf16 v[32:47], v[104:107], v[80:83], v[32:47]
    v_cvt_pk_bf16_f32 v84, v72, v73
    v_exp_f32 v76, v76
    v_exp_f32 v77, v77
    v_cvt_pk_bf16_f32 v85, v74, v75
    v_exp_f32 v78, v78
    v_exp_f32 v79, v79
    v_cvt_pk_bf16_f32 v86, v76, v77
    v_cvt_pk_bf16_f32 v87, v78, v79
    s_waitcnt lgkmcnt(0)
    v_mfma_f32_32x32x16_bf16 v[64:79], v[92:95], v[8:11], v[16:31]
    v_exp_f32 v48, v48
    v_exp_f32 v49, v49
    v_exp_f32 v50, v50
    v_exp_f32 v51, v51
    v_cvt_pk_bf16_f32 v80, v48, v49
    v_exp_f32 v52, v52
    v_exp_f32 v53, v53
    v_cvt_pk_bf16_f32 v81, v50, v51
    v_mfma_f32_32x32x16_bf16 v[32:47], v[108:111], v[84:87], v[32:47]
    ds_read_b128 v[88:91], v13 offset:2048
    s_mov_b64 exec, s[60:61]
    ds_read_b128 v[104:107], v5 offset:5120
    ds_read_b128 v[108:111], v5 offset:5632
    s_mov_b64 exec, -1
    v_exp_f32 v54, v54
    v_exp_f32 v55, v55
    v_cvt_pk_bf16_f32 v82, v52, v53
    s_cbranch_vccnz L_t7_61
    s_add_u32 m0, s96, 0
    s_mov_b32 s3, 917504
    buffer_load_dwordx4 v6, s[20:23], s3 offen  lds
L_t7_61:
    v_exp_f32 v56, v56
    v_exp_f32 v57, v57
    v_cvt_pk_bf16_f32 v83, v54, v55
    v_exp_f32 v58, v58
    v_exp_f32 v59, v59
    v_mfma_f32_32x32x16_bf16 v[32:47], v[96:99], v[80:83], v[32:47]
    v_cvt_pk_bf16_f32 v84, v56, v57
    v_exp_f32 v60, v60
    v_exp_f32 v61, v61
    v_cvt_pk_bf16_f32 v85, v58, v59
    s_cbranch_vccnz L_t7_63
    s_add_u32 m0, s96, 1152
    s_mov_b32 s3, 917504
    buffer_load_dwordx4 v6, s[24:27], s3 offen  lds
L_t7_63:
    v_exp_f32 v62, v62
    v_exp_f32 v63, v63
    v_cvt_pk_bf16_f32 v86, v60, v61
    v_cvt_pk_bf16_f32 v87, v62, v63
    s_waitcnt lgkmcnt(0)
    v_mfma_f32_32x32x16_bf16 v[48:63], v[88:91], v[8:11], v[16:31]
    v_exp_f32 v64, v64
    v_exp_f32 v65, v65
    v_exp_f32 v66, v66
    v_exp_f32 v67, v67
    v_cvt_pk_bf16_f32 v80, v64, v65
    v_exp_f32 v68, v68
    v_exp_f32 v69, v69
    v_cvt_pk_bf16_f32 v81, v66, v67
    v_mfma_f32_32x32x16_bf16 v[32:47], v[100:103], v[84:87], v[32:47]
    ds_read_b128 v[92:95], v13 offset:3072
    s_mov_b64 exec, s[60:61]
    ds_read_b128 v[96:99], v5 offset:6144
    ds_read_b128 v[100:103], v5 offset:6656
    s_mov_b64 exec, -1
    v_exp_f32 v70, v70
    v_exp_f32 v71, v71
    v_cvt_pk_bf16_f32 v82, v68, v69
    v_exp_f32 v72, v72
    v_exp_f32 v73, v73
    v_cvt_pk_bf16_f32 v83, v70, v71
    v_exp_f32 v74, v74
    v_exp_f32 v75, v75
    v_mfma_f32_32x32x16_bf16 v[32:47], v[104:107], v[80:83], v[32:47]
    v_cvt_pk_bf16_f32 v84, v72, v73
    v_exp_f32 v76, v76
    v_exp_f32 v77, v77
    v_cvt_pk_bf16_f32 v85, v74, v75
    v_exp_f32 v78, v78
    v_exp_f32 v79, v79
    v_cvt_pk_bf16_f32 v86, v76, v77
    v_cvt_pk_bf16_f32 v87, v78, v79
    s_waitcnt lgkmcnt(0)
    v_mfma_f32_32x32x16_bf16 v[64:79], v[92:95], v[8:11], v[16:31]
    v_exp_f32 v48, v48
    v_exp_f32 v49, v49
    v_exp_f32 v50, v50
    v_exp_f32 v51, v51
    v_cvt_pk_bf16_f32 v80, v48, v49
    s_waitcnt vmcnt(2)
    ds_read_b64_tr_b16 v[184:185], v116 offset:2176
    ds_read_b64_tr_b16 v[186:187], v116 offset:2304
    v_exp_f32 v52, v52
    v_exp_f32 v53, v53
    v_cvt_pk_bf16_f32 v81, v50, v51
    v_mfma_f32_32x32x16_bf16 v[32:47], v[108:111], v[84:87], v[32:47]
    ds_read_b128 v[88:91], v13 offset:8192
    s_mov_b64 exec, s[60:61]
    ds_read_b128 v[104:107], v5 offset:7168
    ds_read_b128 v[108:111], v5 offset:7680
    s_mov_b64 exec, -1
    v_exp_f32 v54, v54
    v_exp_f32 v55, v55
    v_cvt_pk_bf16_f32 v82, v52, v53
    v_exp_f32 v56, v56
    v_exp_f32 v57, v57
    v_cvt_pk_bf16_f32 v83, v54, v55
    ds_read_b64_tr_b16 v[188:189], v116 offset:2688
    ds_read_b64_tr_b16 v[190:191], v116 offset:2816
    v_exp_f32 v58, v58
    v_exp_f32 v59, v59
    v_mfma_f32_32x32x16_bf16 v[32:47], v[96:99], v[80:83], v[32:47]
    v_cvt_pk_bf16_f32 v84, v56, v57
    v_exp_f32 v60, v60
    v_exp_f32 v61, v61
    v_cvt_pk_bf16_f32 v85, v58, v59
    v_exp_f32 v62, v62
    v_exp_f32 v63, v63
    v_cvt_pk_bf16_f32 v86, v60, v61
    v_cvt_pk_bf16_f32 v87, v62, v63
    s_waitcnt lgkmcnt(0)
    v_mfma_f32_32x32x16_bf16 v[48:63], v[88:91], v[8:11], v[16:31]
    v_exp_f32 v64, v64
    v_exp_f32 v65, v65
    v_exp_f32 v66, v66
    v_exp_f32 v67, v67
    v_cvt_pk_bf16_f32 v80, v64, v65
    v_exp_f32 v68, v68
    v_exp_f32 v69, v69
    v_cvt_pk_bf16_f32 v81, v66, v67
    v_mfma_f32_32x32x16_bf16 v[32:47], v[100:103], v[84:87], v[32:47]
    ds_read_b128 v[92:95], v13 offset:9216
    s_mov_b64 exec, s[60:61]
    ds_read_b128 v[96:99], v5 offset:12288
    ds_read_b128 v[100:103], v5 offset:12800
    s_mov_b64 exec, -1
    v_exp_f32 v70, v70
    v_exp_f32 v71, v71
    v_cvt_pk_bf16_f32 v82, v68, v69
    s_cbranch_vccnz L_t7_65
    s_add_u32 m0, s96, 2176
    s_mov_b32 s3, 1032192
    buffer_load_dwordx4 v6, s[20:23], s3 offen  lds
    s_branch L_t7d_66
L_t7_65:
    s_add_u32 s3, s82, 40960
    buffer_load_dword v14, v15, s[28:31], s3 offen
L_t7d_66:
    v_exp_f32 v72, v72
    v_exp_f32 v73, v73
    v_cvt_pk_bf16_f32 v83, v70, v71
    v_exp_f32 v74, v74
    v_exp_f32 v75, v75
    v_mfma_f32_32x32x16_bf16 v[32:47], v[104:107], v[80:83], v[32:47]
    v_cvt_pk_bf16_f32 v84, v72, v73
    v_exp_f32 v76, v76
    v_exp_f32 v77, v77
    v_cvt_pk_bf16_f32 v85, v74, v75
    s_cbranch_vccnz L_t7_67
    s_add_u32 m0, s96, 3328
    s_mov_b32 s3, 1032192
    buffer_load_dwordx4 v6, s[24:27], s3 offen  lds
L_t7_67:
    v_exp_f32 v78, v78
    v_exp_f32 v79, v79
    v_cvt_pk_bf16_f32 v86, v76, v77
    v_cvt_pk_bf16_f32 v87, v78, v79
    s_cbranch_vccz L_w7_69
    v_and_b32 v3, 31, v1
    v_lshlrev_b32 v3, 3, v3
    s_lshl_b32 s3, s48, 8
    v_add_u32 v3, s3, v3
    s_mov_b32 s87, 12288
    buffer_load_dwordx2 v[136:137], v3, s[44:47], s87 offen sc1
L_w7_69:
    s_waitcnt lgkmcnt(0)
    s_setprio 1
    v_mfma_f32_32x32x16_bf16 v[64:79], v[92:95], v[8:11], v[16:31]
    v_exp_f32 v48, v48
    v_exp_f32 v49, v49
    v_exp_f32 v50, v50
    v_exp_f32 v51, v51
    v_cvt_pk_bf16_f32 v80, v48, v49
    v_exp_f32 v52, v52
    v_exp_f32 v53, v53
    v_cvt_pk_bf16_f32 v81, v50, v51
    v_mfma_f32_32x32x16_bf16 v[32:47], v[108:111], v[84:87], v[32:47]
    ds_read_b128 v[88:91], v13 offset:10240
    s_mov_b64 exec, s[60:61]
    ds_read_b128 v[104:107], v5 offset:13312
    ds_read_b128 v[108:111], v5 offset:13824
    s_mov_b64 exec, -1
    v_exp_f32 v54, v54
    v_exp_f32 v55, v55
    v_cvt_pk_bf16_f32 v82, v52, v53
    v_exp_f32 v56, v56
    v_exp_f32 v57, v57
    v_cvt_pk_bf16_f32 v83, v54, v55
    v_exp_f32 v58, v58
    v_exp_f32 v59, v59
    v_mfma_f32_32x32x16_bf16 v[32:47], v[96:99], v[80:83], v[32:47]
    v_cvt_pk_bf16_f32 v84, v56, v57
    v_exp_f32 v60, v60
    v_exp_f32 v61, v61
    v_cvt_pk_bf16_f32 v85, v58, v59
    v_exp_f32 v62, v62
    v_exp_f32 v63, v63
    v_cvt_pk_bf16_f32 v86, v60, v61
    v_cvt_pk_bf16_f32 v87, v62, v63
    s_waitcnt lgkmcnt(0)
    v_mfma_f32_32x32x16_bf16 v[48:63], v[88:91], v[8:11], v[16:31]
    v_exp_f32 v64, v64
    v_exp_f32 v65, v65
    v_exp_f32 v66, v66
    v_exp_f32 v67, v67
    v_cvt_pk_bf16_f32 v80, v64, v65
    s_waitcnt vmcnt(2)
    ds_read_b64_tr_b16 v[192:193], v116 offset:0
    ds_read_b64_tr_b16 v[194:195], v116 offset:128
    v_exp_f32 v68, v68
    v_exp_f32 v69, v69
    v_cvt_pk_bf16_f32 v81, v66, v67
    v_mfma_f32_32x32x16_bf16 v[32:47], v[100:103], v[84:87], v[32:47]
    ds_read_b128 v[92:95], v13 offset:11264
    s_mov_b64 exec, s[60:61]
    ds_read_b128 v[96:99], v5 offset:14336
    ds_read_b128 v[100:103], v5 offset:14848
    s_mov_b64 exec, -1
    v_exp_f32 v70, v70
    v_exp_f32 v71, v71
    v_cvt_pk_bf16_f32 v82, v68, v69
    v_exp_f32 v72, v72
    v_exp_f32 v73, v73
    v_cvt_pk_bf16_f32 v83, v70, v71
    ds_read_b64_tr_b16 v[196:197], v116 offset:512
    ds_read_b64_tr_b16 v[198:199], v116 offset:640
    v_exp_f32 v74, v74
    v_exp_f32 v75, v75
    v_mfma_f32_32x32x16_bf16 v[32:47], v[104:107], v[80:83], v[32:47]
    v_cvt_pk_bf16_f32 v84, v72, v73
    v_exp_f32 v76, v76
    v_exp_f32 v77, v77
    v_cvt_pk_bf16_f32 v85, v74, v75
    v_exp_f32 v78, v78
    v_exp_f32 v79, v79
    v_cvt_pk_bf16_f32 v86, v76, v77
    v_cvt_pk_bf16_f32 v87, v78, v79
    s_waitcnt lgkmcnt(0)
    v_mfma_f32_32x32x16_bf16 v[64:79], v[92:95], v[8:11], v[16:31]
    v_exp_f32 v48, v48
    v_exp_f32 v49, v49
    v_exp_f32 v50, v50
    v_exp_f32 v51, v51
    v_cvt_pk_bf16_f32 v80, v48, v49
    v_exp_f32 v52, v52
    v_exp_f32 v53, v53
    v_cvt_pk_bf16_f32 v81, v50, v51
    v_mfma_f32_32x32x16_bf16 v[32:47], v[108:111], v[84:87], v[32:47]
    ds_read_b128 v[88:91], v13 offset:16384
    s_mov_b64 exec, s[60:61]
    ds_read_b128 v[104:107], v5 offset:15360
    ds_read_b128 v[108:111], v5 offset:15872
    s_mov_b64 exec, -1
    v_exp_f32 v54, v54
    v_exp_f32 v55, v55
    v_cvt_pk_bf16_f32 v82, v52, v53
    s_cbranch_vccnz L_t7_70
    s_add_u32 m0, s96, 0
    s_mov_b32 s3, 1146880
    buffer_load_dwordx4 v6, s[20:23], s3 offen  lds
L_t7_70:
    v_exp_f32 v56, v56
    v_exp_f32 v57, v57
    v_cvt_pk_bf16_f32 v83, v54, v55
    v_exp_f32 v58, v58
    v_exp_f32 v59, v59
    v_mfma_f32_32x32x16_bf16 v[32:47], v[96:99], v[80:83], v[32:47]
    v_cvt_pk_bf16_f32 v84, v56, v57
    v_exp_f32 v60, v60
    v_exp_f32 v61, v61
    v_cvt_pk_bf16_f32 v85, v58, v59
    s_cbranch_vccnz L_t7_72
    s_add_u32 m0, s96, 1152
    s_mov_b32 s3, 1146880
    buffer_load_dwordx4 v6, s[24:27], s3 offen  lds
    s_branch L_t7d_73
L_t7_72:
    s_add_u32 s3, s82, 49152
    buffer_load_dword v14, v15, s[28:31], s3 offen
L_t7d_73:
    v_exp_f32 v62, v62
    v_exp_f32 v63, v63
    v_cvt_pk_bf16_f32 v86, v60, v61
    v_cvt_pk_bf16_f32 v87, v62, v63
    s_cbranch_vccz L_w7_74
    s_mov_b32 s7, 400000
    s_waitcnt vmcnt(1)
L_pf3_75:
    v_xor_b32 v136, s51, v136
    v_xor_b32 v137, s52, v137
    v_or_b32 v136, v136, v137
    v_cmp_ne_u32 s[4:5], 0, v136
    s_nop 0
    s_cmp_eq_u64 s[4:5], 0
    s_cbranch_scc1 L_pf3d_76
    buffer_load_dwordx2 v[136:137], v3, s[44:47], s87 offen sc1
    s_waitcnt vmcnt(0)
    s_sub_u32 s7, s7, 1
    s_cmp_lg_u32 s7, 0
    s_cbranch_scc1 L_pf3_75
L_pf3d_76:
L_w7_74:
    s_waitcnt lgkmcnt(0)
    s_setprio 0
    v_mfma_f32_32x32x16_bf16 v[48:63], v[88:91], v[8:11], v[16:31]
    v_exp_f32 v64, v64
    v_exp_f32 v65, v65
    v_exp_f32 v66, v66
    v_exp_f32 v67, v67
    v_cvt_pk_bf16_f32 v80, v64, v65
    v_exp_f32 v68, v68
    v_exp_f32 v69, v69
    v_cvt_pk_bf16_f32 v81, v66, v67
    v_mfma_f32_32x32x16_bf16 v[32:47], v[100:103], v[84:87], v[32:47]
    ds_read_b128 v[92:95], v13 offset:17408
    s_mov_b64 exec, s[60:61]
    ds_read_b128 v[96:99], v5 offset:20480
    ds_read_b128 v[100:103], v5 offset:20992
    s_mov_b64 exec, -1
    v_exp_f32 v70, v70
    v_exp_f32 v71, v71
    v_cvt_pk_bf16_f32 v82, v68, v69
    v_exp_f32 v72, v72
    v_exp_f32 v73, v73
    v_cvt_pk_bf16_f32 v83, v70, v71
    v_exp_f32 v74, v74
    v_exp_f32 v75, v75
    v_mfma_f32_32x32x16_bf16 v[32:47], v[104:107], v[80:83], v[32:47]
    v_cvt_pk_bf16_f32 v84, v72, v73
    v_exp_f32 v76, v76
    v_exp_f32 v77, v77
    v_cvt_pk_bf16_f32 v85, v74, v75
    v_exp_f32 v78, v78
    v_exp_f32 v79, v79
    v_cvt_pk_bf16_f32 v86, v76, v77
    v_cvt_pk_bf16_f32 v87, v78, v79
    s_waitcnt lgkmcnt(0)
    s_barrier
    s_setprio 3
    v_mfma_f32_32x32x16_bf16 v[64:79], v[92:95], v[8:11], v[16:31]
    v_exp_f32 v48, v48
    v_exp_f32 v49, v49
    v_exp_f32 v50, v50
    v_exp_f32 v51, v51
    v_cvt_pk_bf16_f32 v80, v48, v49
    s_waitcnt vmcnt(2)
    ds_read_b64_tr_b16 v[200:201], v116 offset:2176
    ds_read_b64_tr_b16 v[202:203], v116 offset:2304
    v_exp_f32 v52, v52
    v_exp_f32 v53, v53
    v_cvt_pk_bf16_f32 v81, v50, v51
    v_mfma_f32_32x32x16_bf16 v[32:47], v[108:111], v[84:87], v[32:47]
    ds_read_b128 v[88:91], v13 offset:18432
    s_mov_b64 exec, s[60:61]
    ds_read_b128 v[104:107], v5 offset:21504
    ds_read_b128 v[108:111], v5 offset:22016
    s_mov_b64 exec, -1
    v_exp_f32 v54, v54
    v_exp_f32 v55, v55
    v_cvt_pk_bf16_f32 v82, v52, v53
    s_add_u32 m0, s97, 0
    s_lshl_b32 s3, s97, 3
    s_add_u32 s3, s3, 0
    buffer_load_dwordx4 v7, s[16:19], s3 offen lds
    v_exp_f32 v56, v56
    v_exp_f32 v57, v57
    v_cvt_pk_bf16_f32 v83, v54, v55
    ds_read_b64_tr_b16 v[204:205], v116 offset:2688
    ds_read_b64_tr_b16 v[206:207], v116 offset:2816
    v_exp_f32 v58, v58
    v_exp_f32 v59, v59
    v_mfma_f32_32x32x16_bf16 v[32:47], v[96:99], v[80:83], v[32:47]
    v_cvt_pk_bf16_f32 v84, v56, v57
    v_exp_f32 v60, v60
    v_exp_f32 v61, v61
    v_cvt_pk_bf16_f32 v85, v58, v59
    s_add_u32 m0, s97, 1024
    s_lshl_b32 s3, s97, 3
    s_add_u32 s3, s3, 8192
    buffer_load_dwordx4 v7, s[16:19], s3 offen lds
    v_exp_f32 v62, v62
    v_exp_f32 v63, v63
    v_cvt_pk_bf16_f32 v86, v60, v61
    v_cvt_pk_bf16_f32 v87, v62, v63
    s_waitcnt lgkmcnt(0)
    v_mfma_f32_32x32x16_bf16 v[48:63], v[88:91], v[8:11], v[16:31]
    v_exp_f32 v64, v64
    v_exp_f32 v65, v65
    v_exp_f32 v66, v66
    v_exp_f32 v67, v67
    v_cvt_pk_bf16_f32 v80, v64, v65
    v_exp_f32 v68, v68
    v_exp_f32 v69, v69
    v_cvt_pk_bf16_f32 v81, v66, v67
    v_mfma_f32_32x32x16_bf16 v[32:47], v[100:103], v[84:87], v[32:47]
    ds_read_b128 v[92:95], v13 offset:19456
    s_mov_b64 exec, s[60:61]
    ds_read_b128 v[96:99], v5 offset:22528
    ds_read_b128 v[100:103], v5 offset:23040
    s_mov_b64 exec, -1
    v_exp_f32 v70, v70
    v_exp_f32 v71, v71
    v_cvt_pk_bf16_f32 v82, v68, v69
    s_cbranch_vccnz L_t7_77
    s_add_u32 m0, s96, 2176
    s_mov_b32 s3, 1261568
    buffer_load_dwordx4 v6, s[20:23], s3 offen  lds
L_t7_77:
    v_exp_f32 v72, v72
    v_exp_f32 v73, v73
    v_cvt_pk_bf16_f32 v83, v70, v71
    v_exp_f32 v74, v74
    v_exp_f32 v75, v75
    v_mfma_f32_32x32x16_bf16 v[32:47], v[104:107], v[80:83], v[32:47]
    v_cvt_pk_bf16_f32 v84, v72, v73
    v_exp_f32 v76, v76
    v_exp_f32 v77, v77
    v_cvt_pk_bf16_f32 v85, v74, v75
    s_cbranch_vccnz L_t7_79
    s_add_u32 m0, s96, 3328
    s_mov_b32 s3, 1261568
    buffer_load_dwordx4 v6, s[24:27], s3 offen  lds
L_t7_79:
    v_exp_f32 v78, v78
    v_exp_f32 v79, v79
    v_cvt_pk_bf16_f32 v86, v76, v77
    v_cvt_pk_bf16_f32 v87, v78, v79
    s_waitcnt lgkmcnt(0)
    v_mfma_f32_32x32x16_bf16 v[64:79], v[92:95], v[8:11], v[16:31]
    v_exp_f32 v48, v48
    v_exp_f32 v49, v49
    v_exp_f32 v50, v50
    v_exp_f32 v51, v51
    v_cvt_pk_bf16_f32 v80, v48, v49
    v_exp_f32 v52, v52
    v_exp_f32 v53, v53
    v_cvt_pk_bf16_f32 v81, v50, v51
    v_mfma_f32_32x32x16_bf16 v[32:47], v[108:111], v[84:87], v[32:47]
    ds_read_b128 v[88:91], v13 offset:24576
    s_mov_b64 exec, s[60:61]
    ds_read_b128 v[104:107], v5 offset:23552
    ds_read_b128 v[108:111], v5 offset:24064
    s_mov_b64 exec, -1
    v_exp_f32 v54, v54
    v_exp_f32 v55, v55
    v_cvt_pk_bf16_f32 v82, v52, v53
    s_add_u32 m0, s97, 2048
    s_lshl_b32 s3, s97, 3
    s_add_u32 s3, s3, 16384
    buffer_load_dwordx4 v7, s[16:19], s3 offen lds
    v_exp_f32 v56, v56
    v_exp_f32 v57, v57
    v_cvt_pk_bf16_f32 v83, v54, v55
    v_exp_f32 v58, v58
    v_exp_f32 v59, v59
    v_mfma_f32_32x32x16_bf16 v[32:47], v[96:99], v[80:83], v[32:47]
    v_cvt_pk_bf16_f32 v84, v56, v57
    v_exp_f32 v60, v60
    v_exp_f32 v61, v61
    v_cvt_pk_bf16_f32 v85, v58, v59
    s_add_u32 m0, s97, 3072
    s_lshl_b32 s3, s97, 3
    s_add_u32 s3, s3, 24576
    buffer_load_dwordx4 v7, s[16:19], s3 offen lds
    v_exp_f32 v62, v62
    v_exp_f32 v63, v63
    v_cvt_pk_bf16_f32 v86, v60, v61
    v_cvt_pk_bf16_f32 v87, v62, v63
    s_waitcnt lgkmcnt(0)
    v_mfma_f32_32x32x16_bf16 v[48:63], v[88:91], v[8:11], v[16:31]
    v_exp_f32 v64, v64
    v_exp_f32 v65, v65
    v_exp_f32 v66, v66
    v_exp_f32 v67, v67
    v_cvt_pk_bf16_f32 v80, v64, v65
    s_waitcnt vmcnt(6)
    ds_read_b64_tr_b16 v[208:209], v116 offset:0
    ds_read_b64_tr_b16 v[210:211], v116 offset:128
    v_exp_f32 v68, v68
    v_exp_f32 v69, v69
    v_cvt_pk_bf16_f32 v81, v66, v67
    v_mfma_f32_32x32x16_bf16 v[32:47], v[100:103], v[84:87], v[32:47]
    ds_read_b128 v[92:95], v13 offset:25600
    s_mov_b64 exec, s[60:61]
    ds_read_b128 v[96:99], v5 offset:28672
    ds_read_b128 v[100:103], v5 offset:29184
    s_mov_b64 exec, -1
    v_exp_f32 v70, v70
    v_exp_f32 v71, v71
    v_cvt_pk_bf16_f32 v82, v68, v69
    s_add_u32 m0, s97, 4096
    s_lshl_b32 s3, s97, 3
    s_add_u32 s3, s3, 32768
    buffer_load_dwordx4 v7, s[16:19], s3 offen lds
    v_exp_f32 v72, v72
    v_exp_f32 v73, v73
    v_cvt_pk_bf16_f32 v83, v70, v71
    ds_read_b64_tr_b16 v[212:213], v116 offset:512
    ds_read_b64_tr_b16 v[214:215], v116 offset:640
    v_exp_f32 v74, v74
    v_exp_f32 v75, v75
    v_mfma_f32_32x32x16_bf16 v[32:47], v[104:107], v[80:83], v[32:47]
    v_cvt_pk_bf16_f32 v84, v72, v73
    v_exp_f32 v76, v76
    v_exp_f32 v77, v77
    v_cvt_pk_bf16_f32 v85, v74, v75
    s_add_u32 m0, s97, 5120
    s_lshl_b32 s3, s97, 3
    s_add_u32 s3, s3, 40960
    buffer_load_dwordx4 v7, s[16:19], s3 offen lds
    v_exp_f32 v78, v78
    v_exp_f32 v79, v79
    v_cvt_pk_bf16_f32 v86, v76, v77
    v_cvt_pk_bf16_f32 v87, v78, v79
    s_waitcnt lgkmcnt(0)
    v_mfma_f32_32x32x16_bf16 v[64:79], v[92:95], v[8:11], v[16:31]
    v_exp_f32 v48, v48
    v_exp_f32 v49, v49
    v_exp_f32 v50, v50
    v_exp_f32 v51, v51
    v_cvt_pk_bf16_f32 v80, v48, v49
    v_exp_f32 v52, v52
    v_exp_f32 v53, v53
    v_cvt_pk_bf16_f32 v81, v50, v51
    v_mfma_f32_32x32x16_bf16 v[32:47], v[108:111], v[84:87], v[32:47]
    ds_read_b128 v[88:91], v13 offset:26624
    s_mov_b64 exec, s[60:61]
    ds_read_b128 v[104:107], v5 offset:29696
    ds_read_b128 v[108:111], v5 offset:30208
    s_mov_b64 exec, -1
    v_exp_f32 v54, v54
    v_exp_f32 v55, v55
    v_cvt_pk_bf16_f32 v82, v52, v53
    s_cbranch_vccnz L_t7_81
    s_add_u32 m0, s96, 0
    s_mov_b32 s3, 1376256
    buffer_load_dwordx4 v6, s[20:23], s3 offen  lds
    s_branch L_t7d_82
L_t7_81:
    s_add_u32 s3, s85, 0
    buffer_load_dword v14, v15, s[44:47], s3 offen
L_t7d_82:
    v_exp_f32 v56, v56
    v_exp_f32 v57, v57
    v_cvt_pk_bf16_f32 v83, v54, v55
    v_exp_f32 v58, v58
    v_exp_f32 v59, v59
    v_mfma_f32_32x32x16_bf16 v[32:47], v[96:99], v[80:83], v[32:47]
    v_cvt_pk_bf16_f32 v84, v56, v57
    v_exp_f32 v60, v60
    v_exp_f32 v61, v61
    v_cvt_pk_bf16_f32 v85, v58, v59
    s_cbranch_vccnz L_t7_83
    s_add_u32 m0, s96, 1152
    s_mov_b32 s3, 1376256
    buffer_load_dwordx4 v6, s[24:27], s3 offen  lds
    s_branch L_t7d_84
L_t7_83:
    s_add_u32 s3, s85, 7168
    buffer_load_dword v14, v15, s[44:47], s3 offen
L_t7d_84:
    v_exp_f32 v62, v62
    v_exp_f32 v63, v63
    v_cvt_pk_bf16_f32 v86, v60, v61
    v_cvt_pk_bf16_f32 v87, v62, v63
    s_waitcnt lgkmcnt(0)
    v_mfma_f32_32x32x16_bf16 v[48:63], v[88:91], v[8:11], v[16:31]
    v_exp_f32 v64, v64
    v_exp_f32 v65, v65
    v_exp_f32 v66, v66
    v_exp_f32 v67, v67
    v_cvt_pk_bf16_f32 v80, v64, v65
    v_exp_f32 v68, v68
    v_exp_f32 v69, v69
    v_cvt_pk_bf16_f32 v81, v66, v67
    v_mfma_f32_32x32x16_bf16 v[32:47], v[100:103], v[84:87], v[32:47]
    ds_read_b128 v[92:95], v13 offset:27648
    s_mov_b64 exec, s[60:61]
    ds_read_b128 v[96:99], v5 offset:30720
    ds_read_b128 v[100:103], v5 offset:31232
    s_mov_b64 exec, -1
    v_exp_f32 v70, v70
    v_exp_f32 v71, v71
    v_cvt_pk_bf16_f32 v82, v68, v69
    s_add_u32 m0, s97, 6144
    s_lshl_b32 s3, s97, 3
    s_add_u32 s3, s3, 49152
    buffer_load_dwordx4 v7, s[16:19], s3 offen lds
    v_exp_f32 v72, v72
    v_exp_f32 v73, v73
    v_cvt_pk_bf16_f32 v83, v70, v71
    v_exp_f32 v74, v74
    v_exp_f32 v75, v75
    v_mfma_f32_32x32x16_bf16 v[32:47], v[104:107], v[80:83], v[32:47]
    v_cvt_pk_bf16_f32 v84, v72, v73
    v_exp_f32 v76, v76
    v_exp_f32 v77, v77
    v_cvt_pk_bf16_f32 v85, v74, v75
    s_add_u32 m0, s97, 7168
    s_lshl_b32 s3, s97, 3
    s_add_u32 s3, s3, 57344
    buffer_load_dwordx4 v7, s[16:19], s3 offen lds
    v_exp_f32 v78, v78
    v_exp_f32 v79, v79
    v_cvt_pk_bf16_f32 v86, v76, v77
    v_cvt_pk_bf16_f32 v87, v78, v79
    s_waitcnt lgkmcnt(0)
    v_mfma_f32_32x32x16_bf16 v[64:79], v[92:95], v[8:11], v[16:31]
    v_exp_f32 v48, v48
    v_exp_f32 v49, v49
    v_exp_f32 v50, v50
    v_exp_f32 v51, v51
    v_cvt_pk_bf16_f32 v80, v48, v49
    s_waitcnt vmcnt(8)
    ds_read_b64_tr_b16 v[216:217], v116 offset:2176
    ds_read_b64_tr_b16 v[218:219], v116 offset:2304
    v_exp_f32 v52, v52
    v_exp_f32 v53, v53
    v_cvt_pk_bf16_f32 v81, v50, v51
    v_mfma_f32_32x32x16_bf16 v[32:47], v[108:111], v[84:87], v[32:47]
    ds_read_b128 v[88:91], v13 offset:32768
    s_mov_b64 exec, s[60:61]
    ds_read_b128 v[104:107], v5 offset:31744
    ds_read_b128 v[108:111], v5 offset:32256
    s_mov_b64 exec, -1
    v_exp_f32 v54, v54
    v_exp_f32 v55, v55
    v_cvt_pk_bf16_f32 v82, v52, v53
    v_exp_f32 v56, v56
    v_exp_f32 v57, v57
    v_cvt_pk_bf16_f32 v83, v54, v55
    ds_read_b64_tr_b16 v[220:221], v116 offset:2688
    ds_read_b64_tr_b16 v[222:223], v116 offset:2816
    v_exp_f32 v58, v58
    v_exp_f32 v59, v59
    v_mfma_f32_32x32x16_bf16 v[32:47], v[96:99], v[80:83], v[32:47]
    v_cvt_pk_bf16_f32 v84, v56, v57
    v_exp_f32 v60, v60
    v_exp_f32 v61, v61
    v_cvt_pk_bf16_f32 v85, v58, v59
    v_exp_f32 v62, v62
    v_exp_f32 v63, v63
    v_cvt_pk_bf16_f32 v86, v60, v61
    v_cvt_pk_bf16_f32 v87, v62, v63
    s_waitcnt lgkmcnt(0)
    v_mfma_f32_32x32x16_bf16 v[48:63], v[88:91], v[8:11], v[16:31]
    v_exp_f32 v64, v64
    v_exp_f32 v65, v65
    v_exp_f32 v66, v66
    v_exp_f32 v67, v67
    v_cvt_pk_bf16_f32 v80, v64, v65
    v_exp_f32 v68, v68
    v_exp_f32 v69, v69
    v_cvt_pk_bf16_f32 v81, v66, v67
    v_mfma_f32_32x32x16_bf16 v[32:47], v[100:103], v[84:87], v[32:47]
    ds_read_b128 v[92:95], v13 offset:33792
    s_mov_b64 exec, s[60:61]
    ds_read_b128 v[96:99], v5 offset:36864
    ds_read_b128 v[100:103], v5 offset:37376
    s_mov_b64 exec, -1
    v_exp_f32 v70, v70
    v_exp_f32 v71, v71
    v_cvt_pk_bf16_f32 v82, v68, v69
    s_cbranch_vccnz L_t7_85
    s_add_u32 m0, s96, 2176
    s_mov_b32 s3, 1490944
    buffer_load_dwordx4 v6, s[20:23], s3 offen  lds
    s_branch L_t7d_86
L_t7_85:
    s_add_u32 s3, s85, 14336
    buffer_load_dword v14, v15, s[44:47], s3 offen
L_t7d_86:
    v_exp_f32 v72, v72
    v_exp_f32 v73, v73
    v_cvt_pk_bf16_f32 v83, v70, v71
    v_exp_f32 v74, v74
    v_exp_f32 v75, v75
    v_mfma_f32_32x32x16_bf16 v[32:47], v[104:107], v[80:83], v[32:47]
    v_cvt_pk_bf16_f32 v84, v72, v73
    v_exp_f32 v76, v76
    v_exp_f32 v77, v77
    v_cvt_pk_bf16_f32 v85, v74, v75
    s_cbranch_vccnz L_t7_87
    s_add_u32 m0, s96, 3328
    s_mov_b32 s3, 1490944
    buffer_load_dwordx4 v6, s[24:27], s3 offen  lds
    s_branch L_t7d_88
L_t7_87:
    s_add_u32 s3, s85, 21504
    buffer_load_dword v14, v15, s[44:47], s3 offen
L_t7d_88:
    v_exp_f32 v78, v78
    v_exp_f32 v79, v79
    v_cvt_pk_bf16_f32 v86, v76, v77
    v_cvt_pk_bf16_f32 v87, v78, v79
    s_waitcnt lgkmcnt(0)
    v_mfma_f32_32x32x16_bf16 v[64:79], v[92:95], v[8:11], v[16:31]
    v_exp_f32 v48, v48
    v_exp_f32 v49, v49
    v_exp_f32 v50, v50
    v_exp_f32 v51, v51
    v_cvt_pk_bf16_f32 v80, v48, v49
    v_exp_f32 v52, v52
    v_exp_f32 v53, v53
    v_cvt_pk_bf16_f32 v81, v50, v51
    v_mfma_f32_32x32x16_bf16 v[32:47], v[108:111], v[84:87], v[32:47]
    ds_read_b128 v[88:91], v13 offset:34816
    s_mov_b64 exec, s[60:61]
    ds_read_b128 v[104:107], v5 offset:37888
    ds_read_b128 v[108:111], v5 offset:38400
    s_mov_b64 exec, -1
    v_exp_f32 v54, v54
    v_exp_f32 v55, v55
    v_cvt_pk_bf16_f32 v82, v52, v53
    v_exp_f32 v56, v56
    v_exp_f32 v57, v57
    v_cvt_pk_bf16_f32 v83, v54, v55
    v_exp_f32 v58, v58
    v_exp_f32 v59, v59
    v_mfma_f32_32x32x16_bf16 v[32:47], v[96:99], v[80:83], v[32:47]
    v_cvt_pk_bf16_f32 v84, v56, v57
    v_exp_f32 v60, v60
    v_exp_f32 v61, v61
    v_cvt_pk_bf16_f32 v85, v58, v59
    v_exp_f32 v62, v62
    v_exp_f32 v63, v63
    v_cvt_pk_bf16_f32 v86, v60, v61
    v_cvt_pk_bf16_f32 v87, v62, v63
    s_waitcnt lgkmcnt(0)
    v_mfma_f32_32x32x16_bf16 v[48:63], v[88:91], v[8:11], v[16:31]
    v_exp_f32 v64, v64
    v_exp_f32 v65, v65
    v_exp_f32 v66, v66
    v_exp_f32 v67, v67
    v_cvt_pk_bf16_f32 v80, v64, v65
    s_waitcnt vmcnt(4)
    ds_read_b64_tr_b16 v[224:225], v116 offset:0
    ds_read_b64_tr_b16 v[226:227], v116 offset:128
    v_exp_f32 v68, v68
    v_exp_f32 v69, v69
    v_cvt_pk_bf16_f32 v81, v66, v67
    v_mfma_f32_32x32x16_bf16 v[32:47], v[100:103], v[84:87], v[32:47]
    ds_read_b128 v[92:95], v13 offset:35840
    s_mov_b64 exec, s[60:61]
    ds_read_b128 v[96:99], v5 offset:38912
    ds_read_b128 v[100:103], v5 offset:39424
    s_mov_b64 exec, -1
    v_exp_f32 v70, v70
    v_exp_f32 v71, v71
    v_cvt_pk_bf16_f32 v82, v68, v69
    v_exp_f32 v72, v72
    v_exp_f32 v73, v73
    v_cvt_pk_bf16_f32 v83, v70, v71
    ds_read_b64_tr_b16 v[228:229], v116 offset:512
    ds_read_b64_tr_b16 v[230:231], v116 offset:640
    v_exp_f32 v74, v74
    v_exp_f32 v75, v75
    v_mfma_f32_32x32x16_bf16 v[32:47], v[104:107], v[80:83], v[32:47]
    v_cvt_pk_bf16_f32 v84, v72, v73
    v_exp_f32 v76, v76
    v_exp_f32 v77, v77
    v_cvt_pk_bf16_f32 v85, v74, v75
    v_exp_f32 v78, v78
    v_exp_f32 v79, v79
    v_cvt_pk_bf16_f32 v86, v76, v77
    v_cvt_pk_bf16_f32 v87, v78, v79
    s_waitcnt lgkmcnt(0)
    v_mfma_f32_32x32x16_bf16 v[64:79], v[92:95], v[8:11], v[16:31]
    v_exp_f32 v48, v48
    v_exp_f32 v49, v49
    v_exp_f32 v50, v50
    v_exp_f32 v51, v51
    v_cvt_pk_bf16_f32 v80, v48, v49
    v_exp_f32 v52, v52
    v_exp_f32 v53, v53
    v_cvt_pk_bf16_f32 v81, v50, v51
    v_mfma_f32_32x32x16_bf16 v[32:47], v[108:111], v[84:87], v[32:47]
    ds_read_b128 v[88:91], v13 offset:40960
    s_mov_b64 exec, s[60:61]
    ds_read_b128 v[104:107], v5 offset:39936
    ds_read_b128 v[108:111], v5 offset:40448
    s_mov_b64 exec, -1
    v_exp_f32 v54, v54
    v_exp_f32 v55, v55
    v_cvt_pk_bf16_f32 v82, v52, v53
    s_cbranch_vccnz L_t7_89
    s_add_u32 m0, s96, 0
    s_mov_b32 s3, 1605632
    buffer_load_dwordx4 v6, s[20:23], s3 offen  lds
    s_branch L_t7d_90
L_t7_89:
    s_add_u32 s3, s83, 0
    buffer_load_dword v14, v15, s[44:47], s3 offen
L_t7d_90:
    v_exp_f32 v56, v56
    v_exp_f32 v57, v57
    v_cvt_pk_bf16_f32 v83, v54, v55
    v_exp_f32 v58, v58
    v_exp_f32 v59, v59
    v_mfma_f32_32x32x16_bf16 v[32:47], v[96:99], v[80:83], v[32:47]
    v_cvt_pk_bf16_f32 v84, v56, v57
    v_exp_f32 v60, v60
    v_exp_f32 v61, v61
    v_cvt_pk_bf16_f32 v85, v58, v59
    s_cbranch_vccnz L_t7_91
    s_add_u32 m0, s96, 1152
    s_mov_b32 s3, 1605632
    buffer_load_dwordx4 v6, s[24:27], s3 offen  lds
    s_branch L_t7d_92
L_t7_91:
    s_add_u32 s3, s84, 0
    buffer_load_dword v14, v15, s[44:47], s3 offen
L_t7d_92:
    v_exp_f32 v62, v62
    v_exp_f32 v63, v63
    v_cvt_pk_bf16_f32 v86, v60, v61
    v_cvt_pk_bf16_f32 v87, v62, v63
    s_waitcnt lgkmcnt(0)
    v_mfma_f32_32x32x16_bf16 v[48:63], v[88:91], v[8:11], v[16:31]
    v_exp_f32 v64, v64
    v_exp_f32 v65, v65
    v_exp_f32 v66, v66
    v_exp_f32 v67, v67
    v_cvt_pk_bf16_f32 v80, v64, v65
    v_exp_f32 v68, v68
    v_exp_f32 v69, v69
    v_cvt_pk_bf16_f32 v81, v66, v67
    v_mfma_f32_32x32x16_bf16 v[32:47], v[100:103], v[84:87], v[32:47]
    ds_read_b128 v[92:95], v13 offset:41984
    s_mov_b64 exec, s[60:61]
    ds_read_b128 v[96:99], v5 offset:45056
    ds_read_b128 v[100:103], v5 offset:45568
    s_mov_b64 exec, -1
    v_exp_f32 v70, v70
    v_exp_f32 v71, v71
    v_cvt_pk_bf16_f32 v82, v68, v69
    v_exp_f32 v72, v72
    v_exp_f32 v73, v73
    v_cvt_pk_bf16_f32 v83, v70, v71
    v_exp_f32 v74, v74
    v_exp_f32 v75, v75
    v_mfma_f32_32x32x16_bf16 v[32:47], v[104:107], v[80:83], v[32:47]
    v_cvt_pk_bf16_f32 v84, v72, v73
    v_exp_f32 v76, v76
    v_exp_f32 v77, v77
    v_cvt_pk_bf16_f32 v85, v74, v75
    v_exp_f32 v78, v78
    v_exp_f32 v79, v79
    v_cvt_pk_bf16_f32 v86, v76, v77
    v_cvt_pk_bf16_f32 v87, v78, v79
    s_waitcnt lgkmcnt(0)
    v_mfma_f32_32x32x16_bf16 v[64:79], v[92:95], v[8:11], v[16:31]
    v_exp_f32 v48, v48
    v_exp_f32 v49, v49
    v_exp_f32 v50, v50
    v_exp_f32 v51, v51
    v_cvt_pk_bf16_f32 v80, v48, v49
    s_waitcnt vmcnt(2)
    ds_read_b64_tr_b16 v[232:233], v116 offset:2176
    ds_read_b64_tr_b16 v[234:235], v116 offset:2304
    v_exp_f32 v52, v52
    v_exp_f32 v53, v53
    v_cvt_pk_bf16_f32 v81, v50, v51
    v_mfma_f32_32x32x16_bf16 v[32:47], v[108:111], v[84:87], v[32:47]
    ds_read_b128 v[88:91], v13 offset:43008
    s_mov_b64 exec, s[60:61]
    ds_read_b128 v[104:107], v5 offset:46080
    ds_read_b128 v[108:111], v5 offset:46592
    s_mov_b64 exec, -1
    v_exp_f32 v54, v54
    v_exp_f32 v55, v55
    v_cvt_pk_bf16_f32 v82, v52, v53
    v_exp_f32 v56, v56
    v_exp_f32 v57, v57
    v_cvt_pk_bf16_f32 v83, v54, v55
    ds_read_b64_tr_b16 v[236:237], v116 offset:2688
    ds_read_b64_tr_b16 v[238:239], v116 offset:2816
    v_exp_f32 v58, v58
    v_exp_f32 v59, v59
    v_mfma_f32_32x32x16_bf16 v[32:47], v[96:99], v[80:83], v[32:47]
    v_cvt_pk_bf16_f32 v84, v56, v57
    v_exp_f32 v60, v60
    v_exp_f32 v61, v61
    v_cvt_pk_bf16_f32 v85, v58, v59
    v_exp_f32 v62, v62
    v_exp_f32 v63, v63
    v_cvt_pk_bf16_f32 v86, v60, v61
    v_cvt_pk_bf16_f32 v87, v62, v63
    s_waitcnt lgkmcnt(0)
    s_cbranch_vccz L_w7_93
    v_lshrrev_b32 v2, 4, v1
    v_lshlrev_b32 v2, 11, v2
    v_and_b32 v3, 15, v1
    v_lshl_add_u32 v2, v3, 4, v2
    s_lshl_b32 s86, s57, 8
    s_add_u32 s86, s86, 327680
    s_add_u32 s3, s86, 0
    buffer_load_dwordx4 v[128:131], v2, s[44:47], s3 offen sc1
    s_add_u32 s3, s86, 8192
    buffer_load_dwordx4 v[132:135], v2, s[44:47], s3 offen sc1
    s_add_u32 s3, s86, 16384
    buffer_load_dwordx4 v[136:139], v2, s[44:47], s3 offen sc1
    s_add_u32 s3, s86, 24576
    buffer_load_dwordx4 v[140:143], v2, s[44:47], s3 offen sc1
L_w7_93:
    v_mfma_f32_32x32x16_bf16 v[48:63], v[88:91], v[8:11], v[16:31]
    v_exp_f32 v64, v64
    v_exp_f32 v65, v65
    v_exp_f32 v66, v66
    v_exp_f32 v67, v67
    v_cvt_pk_bf16_f32 v80, v64, v65
    v_exp_f32 v68, v68
    v_exp_f32 v69, v69
    v_cvt_pk_bf16_f32 v81, v66, v67
    v_mfma_f32_32x32x16_bf16 v[32:47], v[100:103], v[84:87], v[32:47]
    ds_read_b128 v[92:95], v13 offset:44032
    s_mov_b64 exec, s[60:61]
    ds_read_b128 v[96:99], v5 offset:47104
    ds_read_b128 v[100:103], v5 offset:47616
    s_mov_b64 exec, -1
    v_exp_f32 v70, v70
    v_exp_f32 v71, v71
    v_cvt_pk_bf16_f32 v82, v68, v69
    s_cbranch_vccnz L_t7_94
    s_add_u32 m0, s96, 2176
    s_mov_b32 s3, 1720320
    buffer_load_dwordx4 v6, s[20:23], s3 offen  lds
    s_branch L_t7d_95
L_t7_94:
    s_add_u32 s3, s80, 0
    buffer_load_dword v14, v15, s[44:47], s3 offen
L_t7d_95:
    v_exp_f32 v72, v72
    v_exp_f32 v73, v73
    v_cvt_pk_bf16_f32 v83, v70, v71
    v_exp_f32 v74, v74
    v_exp_f32 v75, v75
    v_mfma_f32_32x32x16_bf16 v[32:47], v[104:107], v[80:83], v[32:47]
    v_cvt_pk_bf16_f32 v84, v72, v73
    v_exp_f32 v76, v76
    v_exp_f32 v77, v77
    v_cvt_pk_bf16_f32 v85, v74, v75
    s_cbranch_vccnz L_t7_96
    s_add_u32 m0, s96, 3328
    s_mov_b32 s3, 1720320
    buffer_load_dwordx4 v6, s[24:27], s3 offen  lds
L_t7_96:
    v_exp_f32 v78, v78
    v_exp_f32 v79, v79
    v_cvt_pk_bf16_f32 v86, v76, v77
    v_cvt_pk_bf16_f32 v87, v78, v79
    s_waitcnt lgkmcnt(0)
    s_setprio 2
    v_mfma_f32_32x32x16_bf16 v[64:79], v[92:95], v[8:11], v[16:31]
    v_exp_f32 v48, v48
    v_exp_f32 v49, v49
    v_exp_f32 v50, v50
    v_exp_f32 v51, v51
    v_cvt_pk_bf16_f32 v80, v48, v49
    v_exp_f32 v52, v52
    v_exp_f32 v53, v53
    v_cvt_pk_bf16_f32 v81, v50, v51
    v_mfma_f32_32x32x16_bf16 v[32:47], v[108:111], v[84:87], v[32:47]
    ds_read_b128 v[88:91], v13 offset:49152
    s_mov_b64 exec, s[60:61]
    ds_read_b128 v[104:107], v5 offset:48128
    ds_read_b128 v[108:111], v5 offset:48640
    s_mov_b64 exec, -1
    v_exp_f32 v54, v54
    v_exp_f32 v55, v55
    v_cvt_pk_bf16_f32 v82, v52, v53
    v_exp_f32 v56, v56
    v_exp_f32 v57, v57
    v_cvt_pk_bf16_f32 v83, v54, v55
    v_exp_f32 v58, v58
    v_exp_f32 v59, v59
    v_mfma_f32_32x32x16_bf16 v[32:47], v[96:99], v[80:83], v[32:47]
    v_cvt_pk_bf16_f32 v84, v56, v57
    v_exp_f32 v60, v60
    v_exp_f32 v61, v61
    v_cvt_pk_bf16_f32 v85, v58, v59
    v_exp_f32 v62, v62
    v_exp_f32 v63, v63
    v_cvt_pk_bf16_f32 v86, v60, v61
    v_cvt_pk_bf16_f32 v87, v62, v63
    s_waitcnt lgkmcnt(0)
    v_mfma_f32_32x32x16_bf16 v[48:63], v[88:91], v[8:11], v[16:31]
    v_exp_f32 v64, v64
    v_exp_f32 v65, v65
    v_exp_f32 v66, v66
    v_exp_f32 v67, v67
    v_cvt_pk_bf16_f32 v80, v64, v65
    s_waitcnt vmcnt(2)
    ds_read_b64_tr_b16 v[240:241], v116 offset:0
    ds_read_b64_tr_b16 v[242:243], v116 offset:128
    v_exp_f32 v68, v68
    v_exp_f32 v69, v69
    v_cvt_pk_bf16_f32 v81, v66, v67
    v_mfma_f32_32x32x16_bf16 v[32:47], v[100:103], v[84:87], v[32:47]
    ds_read_b128 v[92:95], v13 offset:50176
    s_mov_b64 exec, s[60:61]
    ds_read_b128 v[96:99], v5 offset:53248
    ds_read_b128 v[100:103], v5 offset:53760
    s_mov_b64 exec, -1
    v_exp_f32 v70, v70
    v_exp_f32 v71, v71
    v_cvt_pk_bf16_f32 v82, v68, v69
    v_exp_f32 v72, v72
    v_exp_f32 v73, v73
    v_cvt_pk_bf16_f32 v83, v70, v71
    ds_read_b64_tr_b16 v[244:245], v116 offset:512
    ds_read_b64_tr_b16 v[246:247], v116 offset:640
    v_exp_f32 v74, v74
    v_exp_f32 v75, v75
    v_mfma_f32_32x32x16_bf16 v[32:47], v[104:107], v[80:83], v[32:47]
    v_cvt_pk_bf16_f32 v84, v72, v73
    v_exp_f32 v76, v76
    v_exp_f32 v77, v77
    v_cvt_pk_bf16_f32 v85, v74, v75
    v_exp_f32 v78, v78
    v_exp_f32 v79, v79
    v_cvt_pk_bf16_f32 v86, v76, v77
    v_cvt_pk_bf16_f32 v87, v78, v79
    s_waitcnt lgkmcnt(0)
    v_mfma_f32_32x32x16_bf16 v[64:79], v[92:95], v[8:11], v[16:31]
    v_exp_f32 v48, v48
    v_exp_f32 v49, v49
    v_exp_f32 v50, v50
    v_exp_f32 v51, v51
    v_cvt_pk_bf16_f32 v80, v48, v49
    v_exp_f32 v52, v52
    v_exp_f32 v53, v53
    v_cvt_pk_bf16_f32 v81, v50, v51
    v_mfma_f32_32x32x16_bf16 v[32:47], v[108:111], v[84:87], v[32:47]
    ds_read_b128 v[88:91], v13 offset:51200
    s_mov_b64 exec, s[60:61]
    ds_read_b128 v[104:107], v5 offset:54272
    ds_read_b128 v[108:111], v5 offset:54784
    s_mov_b64 exec, -1
    v_exp_f32 v54, v54
    v_exp_f32 v55, v55
    v_cvt_pk_bf16_f32 v82, v52, v53
    v_exp_f32 v56, v56
    v_exp_f32 v57, v57
    v_cvt_pk_bf16_f32 v83, v54, v55
    v_exp_f32 v58, v58
    v_exp_f32 v59, v59
    v_mfma_f32_32x32x16_bf16 v[32:47], v[96:99], v[80:83], v[32:47]
    v_cvt_pk_bf16_f32 v84, v56, v57
    v_exp_f32 v60, v60
    v_exp_f32 v61, v61
    v_cvt_pk_bf16_f32 v85, v58, v59
    v_exp_f32 v62, v62
    v_exp_f32 v63, v63
    v_cvt_pk_bf16_f32 v86, v60, v61
    v_cvt_pk_bf16_f32 v87, v62, v63
    s_waitcnt lgkmcnt(0)
    s_cbranch_vccz L_w7_98
    s_mov_b32 s7, 400000
    v_mov_b32 v146, 0x0c0c0400
    v_mov_b32 v147, 0x05040100
L_pml_99:
    s_waitcnt vmcnt(0)
    v_mov_b32 v144, 0
    v_perm_b32 v148, v129, v128, v146
    v_perm_b32 v149, v131, v130, v146
    v_perm_b32 v148, v149, v148, v147
    v_xor_b32 v148, s51, v148
    v_or_b32 v144, v144, v148
    v_perm_b32 v148, v133, v132, v146
    v_perm_b32 v149, v135, v134, v146
    v_perm_b32 v148, v149, v148, v147
    v_xor_b32 v148, s51, v148
    v_or_b32 v144, v144, v148
    v_perm_b32 v148, v137, v136, v146
    v_perm_b32 v149, v139, v138, v146
    v_perm_b32 v148, v149, v148, v147
    v_xor_b32 v148, s51, v148
    v_or_b32 v144, v144, v148
    v_perm_b32 v148, v141, v140, v146
    v_perm_b32 v149, v143, v142, v146
    v_perm_b32 v148, v149, v148, v147
    v_xor_b32 v148, s51, v148
    v_or_b32 v144, v144, v148
    v_cmp_ne_u32 s[4:5], 0, v144
    s_nop 0
    s_cmp_eq_u64 s[4:5], 0
    s_cbranch_scc1 L_pmld_100
    s_add_u32 s3, s86, 0
    buffer_load_dwordx4 v[128:131], v2, s[44:47], s3 offen sc1
    s_add_u32 s3, s86, 8192
    buffer_load_dwordx4 v[132:135], v2, s[44:47], s3 offen sc1
    s_add_u32 s3, s86, 16384
    buffer_load_dwordx4 v[136:139], v2, s[44:47], s3 offen sc1
    s_add_u32 s3, s86, 24576
    buffer_load_dwordx4 v[140:143], v2, s[44:47], s3 offen sc1
    s_sub_u32 s7, s7, 1
    s_cmp_lg_u32 s7, 0
    s_cbranch_scc1 L_pml_99
    s_waitcnt vmcnt(0)
L_pmld_100:
    v_and_b32 v128, 0xffffff00, v128
    v_and_b32 v129, 0xffffff00, v129
    v_and_b32 v130, 0xffffff00, v130
    v_and_b32 v131, 0xffffff00, v131
    v_and_b32 v132, 0xffffff00, v132
    v_and_b32 v133, 0xffffff00, v133
    v_and_b32 v134, 0xffffff00, v134
    v_and_b32 v135, 0xffffff00, v135
    v_and_b32 v136, 0xffffff00, v136
    v_and_b32 v137, 0xffffff00, v137
    v_and_b32 v138, 0xffffff00, v138
    v_and_b32 v139, 0xffffff00, v139
    v_and_b32 v140, 0xffffff00, v140
    v_and_b32 v141, 0xffffff00, v141
    v_and_b32 v142, 0xffffff00, v142
    v_and_b32 v143, 0xffffff00, v143
    v_add_f32 v128, v128, v132
    v_add_f32 v136, v136, v140
    v_add_f32 v129, v129, v133
    v_add_f32 v137, v137, v141
    v_add_f32 v130, v130, v134
    v_add_f32 v138, v138, v142
    v_add_f32 v131, v131, v135
    v_add_f32 v139, v139, v143
    v_add_f32 v128, v128, v136
    v_add_f32 v129, v129, v137
    v_add_f32 v130, v130, v138
    v_add_f32 v131, v131, v139
    v_lshrrev_b32 v146, 4, v1
    v_cmp_eq_u32 s[4:5], 2, v146
    v_mov_b32 v146, 0
    s_nop 0
    v_cndmask_b32 v146, v146, 1.0, s[4:5]
    v_cvt_pk_bf16_f32 v132, v128, v129
    v_cvt_pk_bf16_f32 v133, v130, v131
    v_lshlrev_b32 v128, 16, v132
    v_and_b32 v129, 0xffff0000, v132
    v_lshlrev_b32 v130, 16, v133
    v_and_b32 v131, 0xffff0000, v133
    v_add_f32 v128, v128, v146
    v_add_f32 v129, v129, v146
    v_add_f32 v130, v130, v146
    v_add_f32 v131, v131, v146
    v_cvt_pk_bf16_f32 v132, v128, v129
    v_cvt_pk_bf16_f32 v133, v130, v131
    v_lshlrev_b32 v128, 16, v132
    v_and_b32 v129, 0xffff0000, v132
    v_lshlrev_b32 v130, 16, v133
    v_and_b32 v131, 0xffff0000, v133
    v_add_u32 v146, 161536, v4
    ds_write_b128 v146, v[128:131]
L_w7_98:
    v_mfma_f32_32x32x16_bf16 v[48:63], v[88:91], v[8:11], v[16:31]
    v_exp_f32 v64, v64
    v_exp_f32 v65, v65
    v_exp_f32 v66, v66
    v_exp_f32 v67, v67
    v_cvt_pk_bf16_f32 v80, v64, v65
    v_exp_f32 v68, v68
    v_exp_f32 v69, v69
    v_cvt_pk_bf16_f32 v81, v66, v67
    v_mfma_f32_32x32x16_bf16 v[32:47], v[100:103], v[84:87], v[32:47]
    ds_read_b128 v[92:95], v13 offset:52224
    s_mov_b64 exec, s[60:61]
    ds_read_b128 v[96:99], v5 offset:55296
    ds_read_b128 v[100:103], v5 offset:55808
    s_mov_b64 exec, -1
    v_exp_f32 v70, v70
    v_exp_f32 v71, v71
    v_cvt_pk_bf16_f32 v82, v68, v69
    v_exp_f32 v72, v72
    v_exp_f32 v73, v73
    v_cvt_pk_bf16_f32 v83, v70, v71
    v_exp_f32 v74, v74
    v_exp_f32 v75, v75
    v_mfma_f32_32x32x16_bf16 v[32:47], v[104:107], v[80:83], v[32:47]
    v_cvt_pk_bf16_f32 v84, v72, v73
    v_exp_f32 v76, v76
    v_exp_f32 v77, v77
    v_cvt_pk_bf16_f32 v85, v74, v75
    v_exp_f32 v78, v78
    v_exp_f32 v79, v79
    v_cvt_pk_bf16_f32 v86, v76, v77
    v_cvt_pk_bf16_f32 v87, v78, v79
    s_waitcnt lgkmcnt(0)
    v_mfma_f32_32x32x16_bf16 v[64:79], v[92:95], v[8:11], v[16:31]
    v_exp_f32 v48, v48
    v_exp_f32 v49, v49
    v_exp_f32 v50, v50
    v_exp_f32 v51, v51
    v_cvt_pk_bf16_f32 v80, v48, v49
    s_waitcnt vmcnt(0)
    ds_read_b64_tr_b16 v[248:249], v116 offset:2176
    ds_read_b64_tr_b16 v[250:251], v116 offset:2304
    v_exp_f32 v52, v52
    v_exp_f32 v53, v53
    v_cvt_pk_bf16_f32 v81, v50, v51
    v_mfma_f32_32x32x16_bf16 v[32:47], v[108:111], v[84:87], v[32:47]
    ds_read_b128 v[88:91], v13 offset:57344
    s_mov_b64 exec, s[60:61]
    ds_read_b128 v[104:107], v5 offset:56320
    ds_read_b128 v[108:111], v5 offset:56832
    s_mov_b64 exec, -1
    v_exp_f32 v54, v54
    v_exp_f32 v55, v55
    v_cvt_pk_bf16_f32 v82, v52, v53
    v_exp_f32 v56, v56
    v_exp_f32 v57, v57
    v_cvt_pk_bf16_f32 v83, v54, v55
    ds_read_b64_tr_b16 v[252:253], v116 offset:2688
    ds_read_b64_tr_b16 v[254:255], v116 offset:2816
    v_exp_f32 v58, v58
    v_exp_f32 v59, v59
    v_mfma_f32_32x32x16_bf16 v[32:47], v[96:99], v[80:83], v[32:47]
    v_cvt_pk_bf16_f32 v84, v56, v57
    v_exp_f32 v60, v60
    v_exp_f32 v61, v61
    v_cvt_pk_bf16_f32 v85, v58, v59
    v_exp_f32 v62, v62
    v_exp_f32 v63, v63
    v_cvt_pk_bf16_f32 v86, v60, v61
    v_cvt_pk_bf16_f32 v87, v62, v63
    s_waitcnt lgkmcnt(0)
    v_mfma_f32_32x32x16_bf16 v[48:63], v[88:91], v[8:11], v[16:31]
    v_exp_f32 v64, v64
    v_exp_f32 v65, v65
    v_exp_f32 v66, v66
    v_exp_f32 v67, v67
    v_cvt_pk_bf16_f32 v80, v64, v65
    v_exp_f32 v68, v68
    v_exp_f32 v69, v69
    v_cvt_pk_bf16_f32 v81, v66, v67
    v_mfma_f32_32x32x16_bf16 v[32:47], v[100:103], v[84:87], v[32:47]
    ds_read_b128 v[92:95], v13 offset:58368
    s_mov_b64 exec, s[60:61]
    ds_read_b128 v[96:99], v5 offset:61440
    ds_read_b128 v[100:103], v5 offset:61952
    s_mov_b64 exec, -1
    v_exp_f32 v70, v70
    v_exp_f32 v71, v71
    v_cvt_pk_bf16_f32 v82, v68, v69
    buffer_load_dwordx4 v[120:123], v124, s[8:11], s98 offen
    v_exp_f32 v72, v72
    v_exp_f32 v73, v73
    v_cvt_pk_bf16_f32 v83, v70, v71
    v_exp_f32 v74, v74
    v_exp_f32 v75, v75
    v_mfma_f32_32x32x16_bf16 v[32:47], v[104:107], v[80:83], v[32:47]
    v_cvt_pk_bf16_f32 v84, v72, v73
    v_exp_f32 v76, v76
    v_exp_f32 v77, v77
    v_cvt_pk_bf16_f32 v85, v74, v75
    v_exp_f32 v78, v78
    v_exp_f32 v79, v79
    v_cvt_pk_bf16_f32 v86, v76, v77
    v_cvt_pk_bf16_f32 v87, v78, v79
    s_waitcnt lgkmcnt(0)
    s_setprio 1
    v_mfma_f32_32x32x16_bf16 v[64:79], v[92:95], v[8:11], v[16:31]
    v_exp_f32 v48, v48
    v_exp_f32 v49, v49
    v_exp_f32 v50, v50
    v_exp_f32 v51, v51
    v_cvt_pk_bf16_f32 v80, v48, v49
    v_exp_f32 v52, v52
    v_exp_f32 v53, v53
    v_cvt_pk_bf16_f32 v81, v50, v51
    v_mfma_f32_32x32x16_bf16 v[32:47], v[108:111], v[84:87], v[32:47]
    ds_read_b128 v[88:91], v13 offset:59392
    s_mov_b64 exec, s[60:61]
    ds_read_b128 v[104:107], v5 offset:62464
    ds_read_b128 v[108:111], v5 offset:62976
    s_mov_b64 exec, -1
    v_exp_f32 v54, v54
    v_exp_f32 v55, v55
    v_cvt_pk_bf16_f32 v82, v52, v53
    v_exp_f32 v56, v56
    v_exp_f32 v57, v57
    v_cvt_pk_bf16_f32 v83, v54, v55
    v_exp_f32 v58, v58
    v_exp_f32 v59, v59
    v_mfma_f32_32x32x16_bf16 v[32:47], v[96:99], v[80:83], v[32:47]
    v_cvt_pk_bf16_f32 v84, v56, v57
    v_exp_f32 v60, v60
    v_exp_f32 v61, v61
    v_cvt_pk_bf16_f32 v85, v58, v59
    v_exp_f32 v62, v62
    v_exp_f32 v63, v63
    v_cvt_pk_bf16_f32 v86, v60, v61
    v_cvt_pk_bf16_f32 v87, v62, v63
    s_waitcnt lgkmcnt(0)
    v_mfma_f32_32x32x16_bf16 v[48:63], v[88:91], v[8:11], v[16:31]
    v_exp_f32 v64, v64
    v_exp_f32 v65, v65
    v_exp_f32 v66, v66
    v_exp_f32 v67, v67
    v_cvt_pk_bf16_f32 v80, v64, v65
    v_exp_f32 v68, v68
    v_exp_f32 v69, v69
    v_cvt_pk_bf16_f32 v81, v66, v67
    v_mfma_f32_32x32x16_bf16 v[32:47], v[100:103], v[84:87], v[32:47]
    ds_read_b128 v[92:95], v13 offset:60416
    s_mov_b64 exec, s[60:61]
    ds_read_b128 v[96:99], v5 offset:63488
    ds_read_b128 v[100:103], v5 offset:64000
    s_mov_b64 exec, -1
    v_exp_f32 v70, v70
    v_exp_f32 v71, v71
    v_cvt_pk_bf16_f32 v82, v68, v69
    v_exp_f32 v72, v72
    v_exp_f32 v73, v73
    v_cvt_pk_bf16_f32 v83, v70, v71
    v_exp_f32 v74, v74
    v_exp_f32 v75, v75
    v_mfma_f32_32x32x16_bf16 v[32:47], v[104:107], v[80:83], v[32:47]
    v_cvt_pk_bf16_f32 v84, v72, v73
    v_exp_f32 v76, v76
    v_exp_f32 v77, v77
    v_cvt_pk_bf16_f32 v85, v74, v75
    v_exp_f32 v78, v78
    v_exp_f32 v79, v79
    v_cvt_pk_bf16_f32 v86, v76, v77
    v_cvt_pk_bf16_f32 v87, v78, v79
    s_waitcnt lgkmcnt(0)
    v_mfma_f32_32x32x16_bf16 v[64:79], v[92:95], v[8:11], v[16:31]
    v_exp_f32 v48, v48
    v_exp_f32 v49, v49
    v_exp_f32 v50, v50
    v_exp_f32 v51, v51
    v_cvt_pk_bf16_f32 v80, v48, v49
    v_exp_f32 v52, v52
    v_exp_f32 v53, v53
    v_cvt_pk_bf16_f32 v81, v50, v51
    v_mfma_f32_32x32x16_bf16 v[32:47], v[108:111], v[84:87], v[32:47]
    s_mov_b64 exec, s[60:61]
    ds_read_b128 v[104:107], v5 offset:64512
    ds_read_b128 v[108:111], v5 offset:65024
    s_mov_b64 exec, -1
    v_exp_f32 v54, v54
    v_exp_f32 v55, v55
    v_cvt_pk_bf16_f32 v82, v52, v53
    v_exp_f32 v56, v56
    v_exp_f32 v57, v57
    v_cvt_pk_bf16_f32 v83, v54, v55
    v_exp_f32 v58, v58
    v_exp_f32 v59, v59
    v_mfma_f32_32x32x16_bf16 v[32:47], v[96:99], v[80:83], v[32:47]
    v_cvt_pk_bf16_f32 v84, v56, v57
    v_exp_f32 v60, v60
    v_exp_f32 v61, v61
    v_cvt_pk_bf16_f32 v85, v58, v59
    v_exp_f32 v62, v62
    v_exp_f32 v63, v63
    v_cvt_pk_bf16_f32 v86, v60, v61
    v_cvt_pk_bf16_f32 v87, v62, v63
    s_waitcnt lgkmcnt(0)
    s_setprio 0
    v_exp_f32 v64, v64
    v_exp_f32 v65, v65
    v_exp_f32 v66, v66
    v_exp_f32 v67, v67
    v_cvt_pk_bf16_f32 v80, v64, v65
    v_exp_f32 v68, v68
    v_exp_f32 v69, v69
    v_cvt_pk_bf16_f32 v81, v66, v67
    v_mfma_f32_32x32x16_bf16 v[32:47], v[100:103], v[84:87], v[32:47]
    v_exp_f32 v70, v70
    v_exp_f32 v71, v71
    v_cvt_pk_bf16_f32 v82, v68, v69
    v_exp_f32 v72, v72
    v_exp_f32 v73, v73
    v_cvt_pk_bf16_f32 v83, v70, v71
    v_exp_f32 v74, v74
    v_exp_f32 v75, v75
    v_mfma_f32_32x32x16_bf16 v[32:47], v[104:107], v[80:83], v[32:47]
    v_cvt_pk_bf16_f32 v84, v72, v73
    v_exp_f32 v76, v76
    v_exp_f32 v77, v77
    v_cvt_pk_bf16_f32 v85, v74, v75
    v_exp_f32 v78, v78
    v_exp_f32 v79, v79
    v_cvt_pk_bf16_f32 v86, v76, v77
    v_cvt_pk_bf16_f32 v87, v78, v79
    s_nop 1
    v_mfma_f32_32x32x16_bf16 v[32:47], v[108:111], v[84:87], v[32:47]
    s_setprio 0
    v_subrev_u32 v5, 65536, v5
    s_mov_b32 s3, 0x53800000
    s_nop 8
    v_cmp_nlt_f32_e64 vcc, v40, s3
    s_nop 0
    s_cmp_eq_u64 vcc, 0
    s_cbranch_scc1 L_attok_101
    s_add_u32 s3, s100, 1310720
    s_add_u32 s4, s3, 65536
    v_mov_b32 v2, 0xff800000
L_fb1_102:
    buffer_load_dwordx4 v[88:91], v4, s[44:47], s3 offen sc1
    s_waitcnt vmcnt(0)
    v_mfma_f32_32x32x16_bf16 v[48:63], v[88:91], v[8:11], 0
    s_nop 11
    v_max3_f32 v3, v48, v49, v50
    v_max3_f32 v3, v3, v51, v52
    v_max3_f32 v3, v3, v53, v54
    v_max3_f32 v3, v3, v55, v56
    v_max3_f32 v3, v3, v57, v58
    v_max3_f32 v3, v3, v59, v60
    v_max3_f32 v3, v3, v61, v62
    v_max_f32 v3, v3, v63
    v_max_f32 v2, v2, v3
    s_add_u32 s3, s3, 1024
    s_cmp_lt_u32 s3, s4
    s_cbranch_scc1 L_fb1_102
    v_mov_b32 v3, v2
    s_nop 1
    v_permlane32_swap_b32 v2, v3
    v_max_f32 v2, v2, v3
    v_sub_f32 v16, 0, v2
    v_sub_f32 v17, 0, v2
    v_sub_f32 v18, 0, v2
    v_sub_f32 v19, 0, v2
    v_sub_f32 v20, 0, v2
    v_sub_f32 v21, 0, v2
    v_sub_f32 v22, 0, v2
    v_sub_f32 v23, 0, v2
    v_sub_f32 v24, 0, v2
    v_sub_f32 v25, 0, v2
    v_sub_f32 v26, 0, v2
    v_sub_f32 v27, 0, v2
    v_sub_f32 v28, 0, v2
    v_sub_f32 v29, 0, v2
    v_sub_f32 v30, 0, v2
    v_sub_f32 v31, 0, v2
    v_mov_b32 v32, 0
    v_mov_b32 v33, 0
    v_mov_b32 v34, 0
    v_mov_b32 v35, 0
    v_mov_b32 v36, 0
    v_mov_b32 v37, 0
    v_mov_b32 v38, 0
    v_mov_b32 v39, 0
    v_mov_b32 v40, 0
    v_mov_b32 v41, 0
    v_mov_b32 v42, 0
    v_mov_b32 v43, 0
    v_mov_b32 v44, 0
    v_mov_b32 v45, 0
    v_mov_b32 v46, 0
    v_mov_b32 v47, 0
    s_add_u32 s3, s100, 1310720
    s_add_u32 s5, s100, 1572864
L_fb2_103:
    buffer_load_dwordx4 v[88:91], v4, s[44:47], s3 offen sc1
    s_mov_b64 exec, s[60:61]
    buffer_load_dwordx4 v[96:99], v5, s[44:47], s5 offen sc1
    buffer_load_dwordx4 v[100:103], v5, s[44:47], s5 offen offset:512 sc1
    s_mov_b64 exec, -1
    s_waitcnt vmcnt(0)
    v_mfma_f32_32x32x16_bf16 v[48:63], v[88:91], v[8:11], v[16:31]
    s_nop 11
    v_exp_f32 v48, v48
    v_exp_f32 v49, v49
    v_exp_f32 v50, v50
    v_exp_f32 v51, v51
    v_exp_f32 v52, v52
    v_exp_f32 v53, v53
    v_exp_f32 v54, v54
    v_exp_f32 v55, v55
    v_exp_f32 v56, v56
    v_exp_f32 v57, v57
    v_exp_f32 v58, v58
    v_exp_f32 v59, v59
    v_exp_f32 v60, v60
    v_exp_f32 v61, v61
    v_exp_f32 v62, v62
    v_exp_f32 v63, v63
    v_cvt_pk_bf16_f32 v80, v48, v49
    v_cvt_pk_bf16_f32 v81, v50, v51
    v_cvt_pk_bf16_f32 v82, v52, v53
    v_cvt_pk_bf16_f32 v83, v54, v55
    v_cvt_pk_bf16_f32 v84, v56, v57
    v_cvt_pk_bf16_f32 v85, v58, v59
    v_cvt_pk_bf16_f32 v86, v60, v61
    v_cvt_pk_bf16_f32 v87, v62, v63
    v_mfma_f32_32x32x16_bf16 v[32:47], v[96:99], v[80:83], v[32:47]
    s_nop 0
    v_mfma_f32_32x32x16_bf16 v[32:47], v[100:103], v[84:87], v[32:47]
    s_add_u32 s3, s3, 1024
    s_add_u32 s5, s5, 1024
    s_cmp_lt_u32 s3, s4
    s_cbranch_scc1 L_fb2_103
L_attok_101:
    s_nop 7
    v_rcp_f32 v2, v40
    s_nop 0
    v_mul_f32 v32, v32, v2
    v_mul_f32 v33, v33, v2
    v_mul_f32 v34, v34, v2
    v_mul_f32 v35, v35, v2
    v_mul_f32 v36, v36, v2
    v_mul_f32 v37, v37, v2
    v_mul_f32 v38, v38, v2
    v_mul_f32 v39, v39, v2
    v_cvt_pk_bf16_f32 v80, v32, v33
    v_cvt_pk_bf16_f32 v81, v34, v35
    v_cvt_pk_bf16_f32 v82, v36, v37
    v_cvt_pk_bf16_f32 v83, v38, v39
    v_min_u32 v80, 0xfffffffe, v80
    v_min_u32 v81, 0xfffffffe, v81
    v_min_u32 v82, 0xfffffffe, v82
    v_min_u32 v83, 0xfffffffe, v83
    buffer_store_dwordx4 v[80:83], v4, s[44:47], s99 offen sc1
    s_waitcnt vmcnt(1)
    s_lshl_b32 s3, s89, 14
    s_add_u32 s3, s3, 0
    v_add_u32 v14, s3, v127
    v_xor_b32 v15, 64, v14
    s_add_u32 s6, s101, 4096
    s_mov_b32 s7, 400000
    s_waitcnt lgkmcnt(0)
    s_barrier
    buffer_load_dwordx4 v[64:67], v4, s[44:47], s101 offen offset:0 sc1
    buffer_load_dwordx4 v[68:71], v4, s[44:47], s101 offen offset:1024 sc1
    buffer_load_dwordx4 v[72:75], v4, s[44:47], s101 offen offset:2048 sc1
    buffer_load_dwordx4 v[76:79], v4, s[44:47], s101 offen offset:3072 sc1
    buffer_load_dwordx4 v[80:83], v4, s[44:47], s6 offen offset:0 sc1
    buffer_load_dwordx4 v[84:87], v4, s[44:47], s6 offen offset:1024 sc1
    buffer_load_dwordx4 v[88:91], v4, s[44:47], s6 offen offset:2048 sc1
    buffer_load_dwordx4 v[92:95], v4, s[44:47], s6 offen offset:3072 sc1
    v_and_b32 v2, 7, v1
    v_lshlrev_b32 v2, 5, v2
    v_add_u32 v2, 161536, v2
    ds_read_b128 v[16:19], v2 offset:0
    ds_read_b128 v[20:23], v2 offset:16
    ds_read_b128 v[112:115], v2 offset:256
    ds_read_b128 v[116:119], v2 offset:272
    ds_read_b128 v[24:27], v2 offset:512
    ds_read_b128 v[28:31], v2 offset:528
    ds_read_b128 v[48:51], v2 offset:768
    ds_read_b128 v[52:55], v2 offset:784
    v_lshrrev_b32 v5, 3, v1
    v_lshlrev_b32 v5, 7, v5
    s_lshl_b32 s3, s88, 2
    s_add_u32 s3, s3, s89
    s_lshl_b32 s3, s3, 10
    s_add_u32 s86, s3, 65536
    s_lshl_b32 s4, s57, 4
    s_add_u32 s87, s4, s86
    v_and_b32 v2, 7, v1
    v_lshlrev_b32 v2, 9, v2
    v_lshrrev_b32 v3, 3, v1
    v_lshl_add_u32 v6, v3, 4, v2
    s_lshl_b32 s3, s88, 15
    s_lshl_b32 s4, s57, 12
    s_add_u32 s3, s3, s4
    s_and_b32 s4, s50, 3
    s_lshl_b32 s4, s4, 7
    s_add_u32 s3, s3, s4
    s_add_u32 s94, s3, 9437184
    s_waitcnt lgkmcnt(0)
    v_cvt_pk_bf16_f32 v8, v48, v49
    v_cvt_pk_bf16_f32 v9, v50, v51
    v_cvt_pk_bf16_f32 v10, v52, v53
    v_cvt_pk_bf16_f32 v11, v54, v55
    ds_read_b64_tr_b16 v[96:97], v14 offset:0
    ds_read_b64_tr_b16 v[98:99], v14 offset:1024
    ds_read_b64_tr_b16 v[100:101], v15 offset:0
    ds_read_b64_tr_b16 v[102:103], v15 offset:1024
    ds_read_b64_tr_b16 v[104:105], v14 offset:2048
    ds_read_b64_tr_b16 v[106:107], v14 offset:3072
    ds_read_b64_tr_b16 v[108:109], v15 offset:2048
    ds_read_b64_tr_b16 v[110:111], v15 offset:3072
    s_waitcnt vmcnt(4)
L_pao_104:
    v_max3_u32 v3, v64, v65, v66
    v_max3_u32 v2, v67, v68, v69
    v_max3_u32 v3, v3, v70, v71
    v_max3_u32 v2, v2, v72, v73
    v_max3_u32 v3, v3, v74, v75
    v_max3_u32 v2, v2, v76, v77
    v_max3_u32 v3, v3, v78, v79
    v_max_u32 v3, v3, v2
    v_cmp_eq_u32 vcc, -1, v3
    s_nop 0
    s_cmp_eq_u64 vcc, 0
    s_cbranch_scc1 L_paod_105
    buffer_load_dwordx4 v[64:67], v4, s[44:47], s101 offen offset:0 sc1
    buffer_load_dwordx4 v[68:71], v4, s[44:47], s101 offen offset:1024 sc1
    buffer_load_dwordx4 v[72:75], v4, s[44:47], s101 offen offset:2048 sc1
    buffer_load_dwordx4 v[76:79], v4, s[44:47], s101 offen offset:3072 sc1
    s_waitcnt vmcnt(0)
    s_sub_u32 s7, s7, 1
    s_cmp_lg_u32 s7, 0
    s_cbranch_scc1 L_pao_104
L_paod_105:
    s_waitcnt lgkmcnt(4)
    v_mfma_f32_32x32x16_bf16 v[32:47], v[96:99], v[64:67], 0
    v_mfma_f32_32x32x16_bf16 v[48:63], v[100:103], v[64:67], 0
    ds_read_b64_tr_b16 v[96:97], v14 offset:4096
    ds_read_b64_tr_b16 v[98:99], v14 offset:5120
    ds_read_b64_tr_b16 v[100:101], v15 offset:4096
    ds_read_b64_tr_b16 v[102:103], v15 offset:5120
    s_waitcnt lgkmcnt(4)
    v_mfma_f32_32x32x16_bf16 v[32:47], v[104:107], v[68:71], v[32:47]
    v_mfma_f32_32x32x16_bf16 v[48:63], v[108:111], v[68:71], v[48:63]
    ds_read_b64_tr_b16 v[104:105], v14 offset:6144
    ds_read_b64_tr_b16 v[106:107], v14 offset:7168
    ds_read_b64_tr_b16 v[108:109], v15 offset:6144
    ds_read_b64_tr_b16 v[110:111], v15 offset:7168
    s_waitcnt lgkmcnt(4)
    v_mfma_f32_32x32x16_bf16 v[32:47], v[96:99], v[72:75], v[32:47]
    v_mfma_f32_32x32x16_bf16 v[48:63], v[100:103], v[72:75], v[48:63]
    ds_read_b64_tr_b16 v[96:97], v14 offset:8192
    ds_read_b64_tr_b16 v[98:99], v14 offset:9216
    ds_read_b64_tr_b16 v[100:101], v15 offset:8192
    ds_read_b64_tr_b16 v[102:103], v15 offset:9216
    s_waitcnt lgkmcnt(4)
    v_mfma_f32_32x32x16_bf16 v[32:47], v[104:107], v[76:79], v[32:47]
    v_mfma_f32_32x32x16_bf16 v[48:63], v[108:111], v[76:79], v[48:63]
    ds_read_b64_tr_b16 v[104:105], v14 offset:10240
    ds_read_b64_tr_b16 v[106:107], v14 offset:11264
    ds_read_b64_tr_b16 v[108:109], v15 offset:10240
    ds_read_b64_tr_b16 v[110:111], v15 offset:11264
    s_waitcnt vmcnt(0)
L_pao_106:
    v_max3_u32 v3, v80, v81, v82
    v_max3_u32 v2, v83, v84, v85
    v_max3_u32 v3, v3, v86, v87
    v_max3_u32 v2, v2, v88, v89
    v_max3_u32 v3, v3, v90, v91
    v_max3_u32 v2, v2, v92, v93
    v_max3_u32 v3, v3, v94, v95
    v_max_u32 v3, v3, v2
    v_cmp_eq_u32 vcc, -1, v3
    s_nop 0
    s_cmp_eq_u64 vcc, 0
    s_cbranch_scc1 L_paod_107
    buffer_load_dwordx4 v[80:83], v4, s[44:47], s6 offen offset:0 sc1
    buffer_load_dwordx4 v[84:87], v4, s[44:47], s6 offen offset:1024 sc1
    buffer_load_dwordx4 v[88:91], v4, s[44:47], s6 offen offset:2048 sc1
    buffer_load_dwordx4 v[92:95], v4, s[44:47], s6 offen offset:3072 sc1
    s_waitcnt vmcnt(0)
    s_sub_u32 s7, s7, 1
    s_cmp_lg_u32 s7, 0
    s_cbranch_scc1 L_pao_106
L_paod_107:
    s_waitcnt lgkmcnt(4)
    v_mfma_f32_32x32x16_bf16 v[32:47], v[96:99], v[80:83], v[32:47]
    v_mfma_f32_32x32x16_bf16 v[48:63], v[100:103], v[80:83], v[48:63]
    ds_read_b64_tr_b16 v[96:97], v14 offset:12288
    ds_read_b64_tr_b16 v[98:99], v14 offset:13312
    ds_read_b64_tr_b16 v[100:101], v15 offset:12288
    ds_read_b64_tr_b16 v[102:103], v15 offset:13312
    s_waitcnt lgkmcnt(4)
    v_mfma_f32_32x32x16_bf16 v[32:47], v[104:107], v[84:87], v[32:47]
    v_mfma_f32_32x32x16_bf16 v[48:63], v[108:111], v[84:87], v[48:63]
    ds_read_b64_tr_b16 v[104:105], v14 offset:14336
    ds_read_b64_tr_b16 v[106:107], v14 offset:15360
    ds_read_b64_tr_b16 v[108:109], v15 offset:14336
    ds_read_b64_tr_b16 v[110:111], v15 offset:15360
    s_waitcnt lgkmcnt(4)
    v_mfma_f32_32x32x16_bf16 v[32:47], v[96:99], v[88:91], v[32:47]
    v_mfma_f32_32x32x16_bf16 v[48:63], v[100:103], v[88:91], v[48:63]
    s_waitcnt lgkmcnt(0)
    v_mfma_f32_32x32x16_bf16 v[32:47], v[104:107], v[92:95], v[32:47]
    v_mfma_f32_32x32x16_bf16 v[48:63], v[108:111], v[92:95], v[48:63]
    v_add_u32 v2, 65536, v125
    s_nop 9
    ds_write_b128 v2, v[32:35]
    v_xor_b32 v97, 16, v2
    ds_write_b128 v97, v[36:39]
    v_xor_b32 v98, 32, v2
    ds_write_b128 v98, v[40:43]
    v_xor_b32 v99, 48, v2
    ds_write_b128 v99, v[44:47]
    v_xor_b32 v100, 64, v2
    ds_write_b128 v100, v[48:51]
    v_xor_b32 v101, 80, v2
    ds_write_b128 v101, v[52:55]
    v_xor_b32 v102, 96, v2
    ds_write_b128 v102, v[56:59]
    v_xor_b32 v103, 112, v2
    ds_write_b128 v103, v[60:63]
    v_lshlrev_b32 v72, 16, v120
    v_and_b32 v73, 0xffff0000, v120
    v_lshlrev_b32 v74, 16, v121
    v_and_b32 v75, 0xffff0000, v121
    v_lshlrev_b32 v76, 16, v122
    v_and_b32 v77, 0xffff0000, v122
    v_lshlrev_b32 v78, 16, v123
    v_and_b32 v79, 0xffff0000, v123
    v_add_u32 v2, 65536, v126
    v_xor_b32 v3, 128, v2
    s_waitcnt lgkmcnt(0)
    s_barrier
    ds_read_b128 v[32:35], v2 offset:0
    ds_read_b128 v[36:39], v3 offset:0
    ds_read_b128 v[40:43], v2 offset:16384
    ds_read_b128 v[44:47], v3 offset:16384
    ds_read_b128 v[48:51], v2 offset:32768
    ds_read_b128 v[52:55], v3 offset:32768
    ds_read_b128 v[56:59], v2 offset:49152
    ds_read_b128 v[60:63], v3 offset:49152
    s_waitcnt lgkmcnt(4)
    v_pk_add_f32 v[64:65], v[32:33], v[40:41]
    v_pk_add_f32 v[66:67], v[34:35], v[42:43]
    v_pk_add_f32 v[68:69], v[36:37], v[44:45]
    v_pk_add_f32 v[70:71], v[38:39], v[46:47]
    s_waitcnt lgkmcnt(0)
    v_pk_add_f32 v[48:49], v[48:49], v[56:57]
    v_pk_add_f32 v[50:51], v[50:51], v[58:59]
    v_pk_add_f32 v[52:53], v[52:53], v[60:61]
    v_pk_add_f32 v[54:55], v[54:55], v[62:63]
    v_pk_add_f32 v[64:65], v[64:65], v[48:49]
    v_pk_add_f32 v[66:67], v[66:67], v[50:51]
    v_pk_add_f32 v[68:69], v[68:69], v[52:53]
    v_pk_add_f32 v[70:71], v[70:71], v[54:55]
    v_pk_fma_f32 v[72:73], v[64:65], v[16:17], v[72:73]
    v_pk_fma_f32 v[74:75], v[66:67], v[18:19], v[74:75]
    v_pk_fma_f32 v[76:77], v[68:69], v[20:21], v[76:77]
    v_pk_fma_f32 v[78:79], v[70:71], v[22:23], v[78:79]
    v_cvt_pk_bf16_f32 v120, v72, v73
    v_cvt_pk_bf16_f32 v121, v74, v75
    v_cvt_pk_bf16_f32 v122, v76, v77
    v_cvt_pk_bf16_f32 v123, v78, v79
    s_mov_b32 s3, 0x3f803f80
    v_dot2_f32_bf16 v80, v120, s3, 0
    v_dot2_f32_bf16 v82, v120, v120, 0
    v_dot2_f32_bf16 v80, v121, s3, v80
    v_dot2_f32_bf16 v82, v121, v121, v82
    v_dot2_f32_bf16 v80, v122, s3, v80
    v_dot2_f32_bf16 v82, v122, v122, v82
    v_dot2_f32_bf16 v80, v123, s3, v80
    v_dot2_f32_bf16 v82, v123, v123, v82
    s_nop 1
    v_add_f32_dpp v80, v80, v80 quad_perm:[1,0,3,2] row_mask:0xf bank_mask:0xf
    v_add_f32_dpp v82, v82, v82 quad_perm:[1,0,3,2] row_mask:0xf bank_mask:0xf
    s_nop 0
    v_add_f32_dpp v80, v80, v80 quad_perm:[2,3,0,1] row_mask:0xf bank_mask:0xf
    v_add_f32_dpp v82, v82, v82 quad_perm:[2,3,0,1] row_mask:0xf bank_mask:0xf
    s_nop 0
    v_add_f32_dpp v80, v80, v80 row_half_mirror row_mask:0xf bank_mask:0xf
    v_add_f32_dpp v82, v82, v82 row_half_mirror row_mask:0xf bank_mask:0xf
    v_mov_b32 v81, s51
    v_mov_b32 v83, s52
    s_mov_b32 exec_lo, 0x01010101
    s_mov_b32 exec_hi, 0x01010101
    s_cmp_eq_u32 s53, 1
    s_cbranch_scc1 L_fast_108
    buffer_store_dwordx4 v[80:83], v5, s[44:47], s87 offen sc1
    s_branch L_done_109
L_fast_108:
    buffer_store_dwordx4 v[80:83], v5, s[44:47], s87 offen
L_done_109:
    s_mov_b64 exec, -1
    v_lshlrev_b32 v72, 16, v120
    v_and_b32 v73, 0xffff0000, v120
    v_lshlrev_b32 v74, 16, v121
    v_and_b32 v75, 0xffff0000, v121
    v_lshlrev_b32 v76, 16, v122
    v_and_b32 v77, 0xffff0000, v122
    v_lshlrev_b32 v78, 16, v123
    v_and_b32 v79, 0xffff0000, v123
    s_mov_b32 s7, 400000
L_pst_110:
    buffer_load_dwordx4 v[84:87], v4, s[44:47], s86 offen sc1
    s_waitcnt vmcnt(0)
    v_cmp_ne_u32 vcc, s51, v85
    v_cmp_ne_u32 s[4:5], s52, v87
    s_nop 0
    s_or_b64 vcc, vcc, s[4:5]
    s_cbranch_scc0 L_pstd_111
    s_sub_u32 s7, s7, 1
    s_cmp_lg_u32 s7, 0
    s_cbranch_scc1 L_pst_110
L_pstd_111:
    v_add_f32_dpp v84, v84, v84 quad_perm:[1,0,3,2] row_mask:0xf bank_mask:0xf
    v_add_f32_dpp v86, v86, v86 quad_perm:[1,0,3,2] row_mask:0xf bank_mask:0xf
    s_nop 0
    v_add_f32_dpp v84, v84, v84 quad_perm:[2,3,0,1] row_mask:0xf bank_mask:0xf
    v_add_f32_dpp v86, v86, v86 quad_perm:[2,3,0,1] row_mask:0xf bank_mask:0xf
    s_nop 0
    v_add_f32_dpp v84, v84, v84 row_half_mirror row_mask:0xf bank_mask:0xf
    v_add_f32_dpp v86, v86, v86 row_half_mirror row_mask:0xf bank_mask:0xf
    v_mul_f32 v84, 0x3b000000, v84
    v_mul_f32 v86, 0x3b000000, v86
    v_fma_f32 v86, -v84, v84, v86
    v_max_f32 v86, 0, v86
    v_add_f32 v86, 0x3727c5ac, v86
    v_rsq_f32 v86, v86
    s_nop 0
    v_mul_f32_e64 v87, -v84, v86
    v_pk_fma_f32 v[72:73], v[72:73], v[86:87], v[86:87] op_sel:[0,0,1] op_sel_hi:[1,0,1]
    v_pk_fma_f32 v[74:75], v[74:75], v[86:87], v[86:87] op_sel:[0,0,1] op_sel_hi:[1,0,1]
    v_pk_fma_f32 v[76:77], v[76:77], v[86:87], v[86:87] op_sel:[0,0,1] op_sel_hi:[1,0,1]
    v_pk_fma_f32 v[78:79], v[78:79], v[86:87], v[86:87] op_sel:[0,0,1] op_sel_hi:[1,0,1]
    v_pk_fma_f32 v[72:73], v[72:73], v[24:25], v[112:113]
    v_pk_fma_f32 v[74:75], v[74:75], v[26:27], v[114:115]
    v_pk_fma_f32 v[76:77], v[76:77], v[28:29], v[116:117]
    v_pk_fma_f32 v[78:79], v[78:79], v[30:31], v[118:119]
    v_cvt_pk_bf16_f32 v64, v72, v73
    v_cvt_pk_bf16_f32 v65, v74, v75
    v_cvt_pk_bf16_f32 v66, v76, v77
    v_cvt_pk_bf16_f32 v67, v78, v79
    s_cmp_eq_u32 s53, 1
    s_cbranch_scc1 L_fast_112
    buffer_store_dwordx4 v[64:67], v6, s[44:47], s94 offen sc1
    s_branch L_done_113
L_fast_112:
    buffer_store_dwordx4 v[64:67], v6, s[44:47], s94 offen
L_done_113:
    s_lshr_b32 s100, s56, 7
    s_lshl_b32 s99, s100, 2
    s_lshl_b32 s100, s100, 7
    s_lshl_b32 s6, s48, 8
    s_add_u32 s6, s6, 16384
    s_lshl_b32 s3, s49, 3
    s_add_u32 s3, s3, s6
    s_lshl_b32 s91, s99, 15
    s_lshl_b32 s92, s55, 2
    s_add_u32 s91, s91, s92
    s_add_u32 s91, s91, 9437184
    v_add_u32 v12, 65536, v4
    v_lshlrev_b32 v6, 7, v1
    v_mov_b32 v13, 0xc0135761
    v_and_b32 v0, 15, v1
    v_lshrrev_b32 v3, 5, v1
    v_lshl_add_u32 v0, v3, 4, v0
    v_lshlrev_b32 v0, 4, v0
    v_bfe_u32 v3, v1, 4, 1
    v_lshl_add_u32 v0, v3, 9, v0
    s_mov_b32 s90, 0xbdd2d3e8
    s_and_b32 s59, s99, 7
    s_mul_i32 s59, s59, 114688
    s_lshl_b32 s4, s48, 20
    s_add_u32 s59, s59, s4
    s_mul_i32 s4, s58, 7168
    s_add_u32 s59, s59, s4
    s_add_u32 s59, s59, s55
    s_add_u32 s59, s59, 1048576
    v_mov_b32 v68, s51
    v_mov_b32 v69, s52
    v_mov_b32 v2, 0
    s_waitcnt vmcnt(0) lgkmcnt(0)
    s_barrier
    s_cmp_lg_u32 s50, 0
    s_cbranch_scc1 L_nopoll_114
    s_mov_b64 exec, 1
    s_cmp_eq_u32 s53, 1
    s_cbranch_scc1 L_fast_117
    buffer_store_dwordx2 v[68:69], v2, s[44:47], s3 offen sc1
    s_branch L_done_118
L_fast_117:
    buffer_store_dwordx2 v[68:69], v2, s[44:47], s3 offen
L_done_118:
    s_mov_b64 exec, -1
    v_and_b32 v3, 31, v1
    v_lshlrev_b32 v3, 3, v3
    s_mov_b32 s7, 400000
L_poll_115:
    buffer_load_dwordx2 v[68:69], v3, s[44:47], s6 offen sc1
    s_waitcnt vmcnt(0)
    v_cmp_ne_u32 vcc, s51, v68
    v_cmp_ne_u32 s[4:5], s52, v69
    s_nop 0
    s_or_b64 vcc, vcc, s[4:5]
    s_cbranch_scc0 L_nopoll_114
    s_sub_u32 s7, s7, 1
    s_cmp_lg_u32 s7, 0
    s_cbranch_scc1 L_poll_115
L_nopoll_114:
    s_waitcnt lgkmcnt(0)
    s_barrier
    s_add_u32 m0, s92, 0
    s_add_u32 s3, s91, 0
    buffer_load_dwordx4 v4, s[44:47], s3 offen offset:0 sc1 lds
    buffer_load_dwordx4 v4, s[44:47], s3 offen offset:1024 sc1 lds
    buffer_load_dwordx4 v4, s[44:47], s3 offen offset:2048 sc1 lds
    buffer_load_dwordx4 v4, s[44:47], s3 offen offset:3072 sc1 lds
    s_cmp_eq_u32 s50, 7
    s_cbranch_scc1 L_idle7_119
    s_waitcnt vmcnt(0)
    s_barrier
    ds_read_b128 v[64:67], v4 offset:0
    ds_read_b128 v[68:71], v4 offset:1024
    ds_read_b128 v[72:75], v4 offset:2048
    ds_read_b128 v[76:79], v4 offset:3072
    ds_read_b128 v[80:83], v4 offset:4096
    ds_read_b128 v[84:87], v4 offset:5120
    ds_read_b128 v[88:91], v4 offset:6144
    s_waitcnt lgkmcnt(6)
    v_mfma_f32_32x32x16_bf16 v[32:47], v[128:131], v[64:67], 0
    s_add_u32 m0, s92, 32768
    s_add_u32 s3, s91, 32768
    buffer_load_dwordx4 v4, s[44:47], s3 offen offset:0 sc1 lds
    ds_read_b128 v[92:95], v4 offset:7168
    s_waitcnt lgkmcnt(6)
    v_mfma_f32_32x32x16_bf16 v[32:47], v[132:135], v[68:71], v[32:47]
    ds_read_b128 v[64:67], v4 offset:8192
    s_waitcnt lgkmcnt(6)
    v_mfma_f32_32x32x16_bf16 v[32:47], v[136:139], v[72:75], v[32:47]
    s_add_u32 m0, s92, 32768
    s_add_u32 s3, s91, 32768
    buffer_load_dwordx4 v4, s[44:47], s3 offen offset:1024 sc1 lds
    ds_read_b128 v[68:71], v4 offset:9216
    s_waitcnt lgkmcnt(6)
    v_mfma_f32_32x32x16_bf16 v[32:47], v[140:143], v[76:79], v[32:47]
    ds_read_b128 v[72:75], v4 offset:10240
    s_waitcnt lgkmcnt(6)
    v_mfma_f32_32x32x16_bf16 v[32:47], v[144:147], v[80:83], v[32:47]
    s_add_u32 m0, s92, 32768
    s_add_u32 s3, s91, 32768
    buffer_load_dwordx4 v4, s[44:47], s3 offen offset:2048 sc1 lds
    ds_read_b128 v[76:79], v4 offset:11264
    s_waitcnt lgkmcnt(6)
    v_mfma_f32_32x32x16_bf16 v[32:47], v[148:151], v[84:87], v[32:47]
    ds_read_b128 v[80:83], v4 offset:12288
    s_waitcnt lgkmcnt(6)
    v_mfma_f32_32x32x16_bf16 v[32:47], v[152:155], v[88:91], v[32:47]
    s_add_u32 m0, s92, 32768
    s_add_u32 s3, s91, 32768
    buffer_load_dwordx4 v4, s[44:47], s3 offen offset:3072 sc1 lds
    ds_read_b128 v[84:87], v4 offset:13312
    s_waitcnt lgkmcnt(6)
    v_mfma_f32_32x32x16_bf16 v[32:47], v[156:159], v[92:95], v[32:47]
    ds_read_b128 v[88:91], v4 offset:14336
    s_waitcnt lgkmcnt(6)
    v_mfma_f32_32x32x16_bf16 v[32:47], v[160:163], v[64:67], v[32:47]
    s_add_u32 m0, s92, 65536
    s_add_u32 s3, s91, 65536
    buffer_load_dwordx4 v4, s[44:47], s3 offen offset:0 sc1 lds
    ds_read_b128 v[92:95], v4 offset:15360
    s_waitcnt lgkmcnt(6)
    v_mfma_f32_32x32x16_bf16 v[32:47], v[164:167], v[68:71], v[32:47]
    ds_read_b128 v[64:67], v4 offset:16384
    s_waitcnt lgkmcnt(6)
    v_mfma_f32_32x32x16_bf16 v[32:47], v[168:171], v[72:75], v[32:47]
    s_add_u32 m0, s92, 65536
    s_add_u32 s3, s91, 65536
    buffer_load_dwordx4 v4, s[44:47], s3 offen offset:1024 sc1 lds
    ds_read_b128 v[68:71], v4 offset:17408
    s_waitcnt lgkmcnt(6)
    v_mfma_f32_32x32x16_bf16 v[32:47], v[172:175], v[76:79], v[32:47]
    ds_read_b128 v[72:75], v4 offset:18432
    s_waitcnt lgkmcnt(6)
    v_mfma_f32_32x32x16_bf16 v[32:47], v[176:179], v[80:83], v[32:47]
    s_add_u32 m0, s92, 65536
    s_add_u32 s3, s91, 65536
    buffer_load_dwordx4 v4, s[44:47], s3 offen offset:2048 sc1 lds
    ds_read_b128 v[76:79], v4 offset:19456
    s_waitcnt lgkmcnt(6)
    v_mfma_f32_32x32x16_bf16 v[32:47], v[180:183], v[84:87], v[32:47]
    ds_read_b128 v[80:83], v4 offset:20480
    s_waitcnt lgkmcnt(6)
    v_mfma_f32_32x32x16_bf16 v[32:47], v[184:187], v[88:91], v[32:47]
    s_add_u32 m0, s92, 65536
    s_add_u32 s3, s91, 65536
    buffer_load_dwordx4 v4, s[44:47], s3 offen offset:3072 sc1 lds
    ds_read_b128 v[84:87], v4 offset:21504
    s_waitcnt lgkmcnt(6)
    v_mfma_f32_32x32x16_bf16 v[32:47], v[188:191], v[92:95], v[32:47]
    ds_read_b128 v[88:91], v4 offset:22528
    s_waitcnt lgkmcnt(6)
    v_mfma_f32_32x32x16_bf16 v[32:47], v[192:195], v[64:67], v[32:47]
    s_add_u32 m0, s92, 98304
    s_add_u32 s3, s91, 98304
    buffer_load_dwordx4 v4, s[44:47], s3 offen offset:0 sc1 lds
    ds_read_b128 v[92:95], v4 offset:23552
    s_waitcnt lgkmcnt(6)
    v_mfma_f32_32x32x16_bf16 v[32:47], v[196:199], v[68:71], v[32:47]
    ds_read_b128 v[64:67], v4 offset:24576
    s_waitcnt lgkmcnt(6)
    v_mfma_f32_32x32x16_bf16 v[32:47], v[200:203], v[72:75], v[32:47]
    s_add_u32 m0, s92, 98304
    s_add_u32 s3, s91, 98304
    buffer_load_dwordx4 v4, s[44:47], s3 offen offset:1024 sc1 lds
    ds_read_b128 v[68:71], v4 offset:25600
    s_waitcnt lgkmcnt(6)
    v_mfma_f32_32x32x16_bf16 v[32:47], v[204:207], v[76:79], v[32:47]
    ds_read_b128 v[72:75], v4 offset:26624
    s_waitcnt lgkmcnt(6)
    v_mfma_f32_32x32x16_bf16 v[32:47], v[208:211], v[80:83], v[32:47]
    s_add_u32 m0, s92, 98304
    s_add_u32 s3, s91, 98304
    buffer_load_dwordx4 v4, s[44:47], s3 offen offset:2048 sc1 lds
    ds_read_b128 v[76:79], v4 offset:27648
    s_waitcnt lgkmcnt(6)
    v_mfma_f32_32x32x16_bf16 v[32:47], v[212:215], v[84:87], v[32:47]
    ds_read_b128 v[80:83], v4 offset:28672
    s_waitcnt lgkmcnt(6)
    v_mfma_f32_32x32x16_bf16 v[32:47], v[216:219], v[88:91], v[32:47]
    s_add_u32 m0, s92, 98304
    s_add_u32 s3, s91, 98304
    buffer_load_dwordx4 v4, s[44:47], s3 offen offset:3072 sc1 lds
    ds_read_b128 v[84:87], v4 offset:29696
    s_waitcnt lgkmcnt(6)
    v_mfma_f32_32x32x16_bf16 v[32:47], v[220:223], v[92:95], v[32:47]
    ds_read_b128 v[88:91], v4 offset:30720
    s_waitcnt lgkmcnt(6)
    v_mfma_f32_32x32x16_bf16 v[32:47], v[224:227], v[64:67], v[32:47]
    ds_read_b128 v[92:95], v4 offset:31744
    s_waitcnt lgkmcnt(6)
    v_mfma_f32_32x32x16_bf16 v[32:47], v[228:231], v[68:71], v[32:47]
    s_waitcnt vmcnt(8)
    s_waitcnt lgkmcnt(0)
    s_barrier
    ds_read_b128 v[64:67], v4 offset:32768
    v_mfma_f32_32x32x16_bf16 v[32:47], v[232:235], v[72:75], v[32:47]
    ds_read_b128 v[68:71], v4 offset:33792
    v_mfma_f32_32x32x16_bf16 v[32:47], v[236:239], v[76:79], v[32:47]
    ds_read_b128 v[72:75], v4 offset:34816
    v_mfma_f32_32x32x16_bf16 v[32:47], v[240:243], v[80:83], v[32:47]
    ds_read_b128 v[76:79], v4 offset:35840
    v_mfma_f32_32x32x16_bf16 v[32:47], v[244:247], v[84:87], v[32:47]
    ds_read_b128 v[80:83], v4 offset:36864
    v_mfma_f32_32x32x16_bf16 v[32:47], v[248:251], v[88:91], v[32:47]
    ds_read_b128 v[84:87], v4 offset:37888
    v_mfma_f32_32x32x16_bf16 v[32:47], v[252:255], v[92:95], v[32:47]
    ds_read_b128 v[88:91], v4 offset:38912
    s_waitcnt lgkmcnt(6)
    v_mfma_f32_32x32x16_bf16 v[48:63], v[128:131], v[64:67], 0
    ds_read_b128 v[92:95], v4 offset:39936
    s_waitcnt lgkmcnt(6)
    v_mfma_f32_32x32x16_bf16 v[48:63], v[132:135], v[68:71], v[48:63]
    ds_read_b128 v[64:67], v4 offset:40960
    s_waitcnt lgkmcnt(6)
    v_mfma_f32_32x32x16_bf16 v[48:63], v[136:139], v[72:75], v[48:63]
    s_nop 2
    v_mul_f32 v96, v32, v32
    v_mul_f32 v97, v33, v33
    v_mul_f32 v98, v34, v34
    v_mul_f32 v99, v35, v35
    ds_read_b128 v[68:71], v4 offset:41984
    s_waitcnt lgkmcnt(6)
    v_mfma_f32_32x32x16_bf16 v[48:63], v[140:143], v[76:79], v[48:63]
    v_mul_f32 v100, v36, v36
    v_mul_f32 v101, v37, v37
    v_mul_f32 v102, v38, v38
    v_mul_f32 v103, v39, v39
    ds_read_b128 v[72:75], v4 offset:43008
    s_waitcnt lgkmcnt(6)
    v_mfma_f32_32x32x16_bf16 v[48:63], v[144:147], v[80:83], v[48:63]
    v_fma_f32 v96, v96, s90, v13
    v_fma_f32 v97, v97, s90, v13
    v_fma_f32 v98, v98, s90, v13
    v_fma_f32 v99, v99, s90, v13
    ds_read_b128 v[76:79], v4 offset:44032
    s_waitcnt lgkmcnt(6)
    v_mfma_f32_32x32x16_bf16 v[48:63], v[148:151], v[84:87], v[48:63]
    v_fma_f32 v100, v100, s90, v13
    v_fma_f32 v101, v101, s90, v13
    v_fma_f32 v102, v102, s90, v13
    v_fma_f32 v103, v103, s90, v13
    ds_read_b128 v[80:83], v4 offset:45056
    s_waitcnt lgkmcnt(6)
    v_mfma_f32_32x32x16_bf16 v[48:63], v[152:155], v[88:91], v[48:63]
    v_mul_f32 v96, v96, v32
    v_mul_f32 v97, v97, v33
    v_mul_f32 v98, v98, v34
    v_mul_f32 v99, v99, v35
    ds_read_b128 v[84:87], v4 offset:46080
    s_waitcnt lgkmcnt(6)
    v_mfma_f32_32x32x16_bf16 v[48:63], v[156:159], v[92:95], v[48:63]
    v_mul_f32 v100, v100, v36
    v_mul_f32 v101, v101, v37
    v_mul_f32 v102, v102, v38
    v_mul_f32 v103, v103, v39
    ds_read_b128 v[88:91], v4 offset:47104
    s_waitcnt lgkmcnt(6)
    v_mfma_f32_32x32x16_bf16 v[48:63], v[160:163], v[64:67], v[48:63]
    v_exp_f32 v96, v96
    v_exp_f32 v97, v97
    v_exp_f32 v98, v98
    v_exp_f32 v99, v99
    ds_read_b128 v[92:95], v4 offset:48128
    s_waitcnt lgkmcnt(6)
    v_mfma_f32_32x32x16_bf16 v[48:63], v[164:167], v[68:71], v[48:63]
    v_exp_f32 v100, v100
    v_exp_f32 v101, v101
    v_exp_f32 v102, v102
    v_exp_f32 v103, v103
    ds_read_b128 v[64:67], v4 offset:49152
    s_waitcnt lgkmcnt(6)
    v_mfma_f32_32x32x16_bf16 v[48:63], v[168:171], v[72:75], v[48:63]
    v_mul_f32 v104, v32, v40
    v_mul_f32 v105, v33, v41
    v_mul_f32 v106, v34, v42
    v_mul_f32 v107, v35, v43
    ds_read_b128 v[68:71], v4 offset:50176
    s_waitcnt lgkmcnt(6)
    v_mfma_f32_32x32x16_bf16 v[48:63], v[172:175], v[76:79], v[48:63]
    v_mul_f32 v108, v36, v44
    v_mul_f32 v109, v37, v45
    v_mul_f32 v110, v38, v46
    v_mul_f32 v111, v39, v47
    ds_read_b128 v[72:75], v4 offset:51200
    s_waitcnt lgkmcnt(6)
    v_mfma_f32_32x32x16_bf16 v[48:63], v[176:179], v[80:83], v[48:63]
    v_add_f32 v96, 1.0, v96
    v_add_f32 v97, 1.0, v97
    v_add_f32 v98, 1.0, v98
    v_add_f32 v99, 1.0, v99
    ds_read_b128 v[76:79], v4 offset:52224
    s_waitcnt lgkmcnt(6)
    v_mfma_f32_32x32x16_bf16 v[48:63], v[180:183], v[84:87], v[48:63]
    v_add_f32 v100, 1.0, v100
    v_add_f32 v101, 1.0, v101
    v_add_f32 v102, 1.0, v102
    v_add_f32 v103, 1.0, v103
    ds_read_b128 v[80:83], v4 offset:53248
    s_waitcnt lgkmcnt(6)
    v_mfma_f32_32x32x16_bf16 v[48:63], v[184:187], v[88:91], v[48:63]
    v_rcp_f32 v96, v96
    v_rcp_f32 v97, v97
    v_rcp_f32 v98, v98
    v_rcp_f32 v99, v99
    ds_read_b128 v[84:87], v4 offset:54272
    s_waitcnt lgkmcnt(6)
    v_mfma_f32_32x32x16_bf16 v[48:63], v[188:191], v[92:95], v[48:63]
    v_rcp_f32 v100, v100
    v_rcp_f32 v101, v101
    v_rcp_f32 v102, v102
    v_rcp_f32 v103, v103
    ds_read_b128 v[88:91], v4 offset:55296
    s_waitcnt lgkmcnt(6)
    v_mfma_f32_32x32x16_bf16 v[48:63], v[192:195], v[64:67], v[48:63]
    v_mul_f32 v104, v104, v96
    v_mul_f32 v105, v105, v97
    v_mul_f32 v106, v106, v98
    v_mul_f32 v107, v107, v99
    ds_read_b128 v[92:95], v4 offset:56320
    s_waitcnt lgkmcnt(6)
    v_mfma_f32_32x32x16_bf16 v[48:63], v[196:199], v[68:71], v[48:63]
    v_mul_f32 v108, v108, v100
    v_mul_f32 v109, v109, v101
    v_mul_f32 v110, v110, v102
    v_mul_f32 v111, v111, v103
    ds_read_b128 v[64:67], v4 offset:57344
    s_waitcnt lgkmcnt(6)
    v_mfma_f32_32x32x16_bf16 v[48:63], v[200:203], v[72:75], v[48:63]
    v_cvt_pk_bf16_f32 v112, v104, v105
    v_cvt_pk_bf16_f32 v113, v106, v107
    v_cvt_pk_bf16_f32 v114, v108, v109
    v_cvt_pk_bf16_f32 v115, v110, v111
    ds_read_b128 v[68:71], v4 offset:58368
    s_waitcnt lgkmcnt(6)
    v_mfma_f32_32x32x16_bf16 v[48:63], v[204:207], v[76:79], v[48:63]
    ds_read_b128 v[72:75], v4 offset:59392
    s_waitcnt lgkmcnt(6)
    v_mfma_f32_32x32x16_bf16 v[48:63], v[208:211], v[80:83], v[48:63]
    s_add_u32 s3, s59, 0
    s_cmp_eq_u32 s53, 1
    s_cbranch_scc1 L_fast_121
    buffer_store_dwordx4 v[112:115], v4, s[44:47], s3 offen sc1
    s_branch L_done_122
L_fast_121:
    buffer_store_dwordx4 v[112:115], v4, s[44:47], s3 offen
L_done_122:
    ds_read_b128 v[76:79], v4 offset:60416
    s_waitcnt lgkmcnt(6)
    v_mfma_f32_32x32x16_bf16 v[48:63], v[212:215], v[84:87], v[48:63]
    ds_read_b128 v[80:83], v4 offset:61440
    s_waitcnt lgkmcnt(6)
    v_mfma_f32_32x32x16_bf16 v[48:63], v[216:219], v[88:91], v[48:63]
    ds_read_b128 v[84:87], v4 offset:62464
    s_waitcnt lgkmcnt(6)
    v_mfma_f32_32x32x16_bf16 v[48:63], v[220:223], v[92:95], v[48:63]
    ds_read_b128 v[88:91], v4 offset:63488
    s_waitcnt lgkmcnt(6)
    v_mfma_f32_32x32x16_bf16 v[48:63], v[224:227], v[64:67], v[48:63]
    ds_read_b128 v[92:95], v4 offset:64512
    s_waitcnt lgkmcnt(6)
    v_mfma_f32_32x32x16_bf16 v[48:63], v[228:231], v[68:71], v[48:63]
    s_waitcnt vmcnt(5)
    s_waitcnt lgkmcnt(0)
    s_barrier
    ds_read_b128 v[64:67], v12 offset:0
    v_mfma_f32_32x32x16_bf16 v[48:63], v[232:235], v[72:75], v[48:63]
    ds_read_b128 v[68:71], v12 offset:1024
    v_mfma_f32_32x32x16_bf16 v[48:63], v[236:239], v[76:79], v[48:63]
    ds_read_b128 v[72:75], v12 offset:2048
    v_mfma_f32_32x32x16_bf16 v[48:63], v[240:243], v[80:83], v[48:63]
    ds_read_b128 v[76:79], v12 offset:3072
    v_mfma_f32_32x32x16_bf16 v[48:63], v[244:247], v[84:87], v[48:63]
    ds_read_b128 v[80:83], v12 offset:4096
    v_mfma_f32_32x32x16_bf16 v[48:63], v[248:251], v[88:91], v[48:63]
    ds_read_b128 v[84:87], v12 offset:5120
    v_mfma_f32_32x32x16_bf16 v[48:63], v[252:255], v[92:95], v[48:63]
    ds_read_b128 v[88:91], v12 offset:6144
    s_waitcnt lgkmcnt(6)
    v_mfma_f32_32x32x16_bf16 v[32:47], v[128:131], v[64:67], 0
    ds_read_b128 v[92:95], v12 offset:7168
    s_waitcnt lgkmcnt(6)
    v_mfma_f32_32x32x16_bf16 v[32:47], v[132:135], v[68:71], v[32:47]
    ds_read_b128 v[64:67], v12 offset:8192
    s_waitcnt lgkmcnt(6)
    v_mfma_f32_32x32x16_bf16 v[32:47], v[136:139], v[72:75], v[32:47]
    s_nop 2
    v_mul_f32 v96, v48, v48
    v_mul_f32 v97, v49, v49
    v_mul_f32 v98, v50, v50
    v_mul_f32 v99, v51, v51
    ds_read_b128 v[68:71], v12 offset:9216
    s_waitcnt lgkmcnt(6)
    v_mfma_f32_32x32x16_bf16 v[32:47], v[140:143], v[76:79], v[32:47]
    v_mul_f32 v100, v52, v52
    v_mul_f32 v101, v53, v53
    v_mul_f32 v102, v54, v54
    v_mul_f32 v103, v55, v55
    ds_read_b128 v[72:75], v12 offset:10240
    s_waitcnt lgkmcnt(6)
    v_mfma_f32_32x32x16_bf16 v[32:47], v[144:147], v[80:83], v[32:47]
    v_fma_f32 v96, v96, s90, v13
    v_fma_f32 v97, v97, s90, v13
    v_fma_f32 v98, v98, s90, v13
    v_fma_f32 v99, v99, s90, v13
    ds_read_b128 v[76:79], v12 offset:11264
    s_waitcnt lgkmcnt(6)
    v_mfma_f32_32x32x16_bf16 v[32:47], v[148:151], v[84:87], v[32:47]
    v_fma_f32 v100, v100, s90, v13
    v_fma_f32 v101, v101, s90, v13
    v_fma_f32 v102, v102, s90, v13
    v_fma_f32 v103, v103, s90, v13
    ds_read_b128 v[80:83], v12 offset:12288
    s_waitcnt lgkmcnt(6)
    v_mfma_f32_32x32x16_bf16 v[32:47], v[152:155], v[88:91], v[32:47]
    v_mul_f32 v96, v96, v48
    v_mul_f32 v97, v97, v49
    v_mul_f32 v98, v98, v50
    v_mul_f32 v99, v99, v51
    ds_read_b128 v[84:87], v12 offset:13312
    s_waitcnt lgkmcnt(6)
    v_mfma_f32_32x32x16_bf16 v[32:47], v[156:159], v[92:95], v[32:47]
    v_mul_f32 v100, v100, v52
    v_mul_f32 v101, v101, v53
    v_mul_f32 v102, v102, v54
    v_mul_f32 v103, v103, v55
    ds_read_b128 v[88:91], v12 offset:14336
    s_waitcnt lgkmcnt(6)
    v_mfma_f32_32x32x16_bf16 v[32:47], v[160:163], v[64:67], v[32:47]
    v_exp_f32 v96, v96
    v_exp_f32 v97, v97
    v_exp_f32 v98, v98
    v_exp_f32 v99, v99
    ds_read_b128 v[92:95], v12 offset:15360
    s_waitcnt lgkmcnt(6)
    v_mfma_f32_32x32x16_bf16 v[32:47], v[164:167], v[68:71], v[32:47]
    v_exp_f32 v100, v100
    v_exp_f32 v101, v101
    v_exp_f32 v102, v102
    v_exp_f32 v103, v103
    ds_read_b128 v[64:67], v12 offset:16384
    s_waitcnt lgkmcnt(6)
    v_mfma_f32_32x32x16_bf16 v[32:47], v[168:171], v[72:75], v[32:47]
    v_mul_f32 v104, v48, v56
    v_mul_f32 v105, v49, v57
    v_mul_f32 v106, v50, v58
    v_mul_f32 v107, v51, v59
    ds_read_b128 v[68:71], v12 offset:17408
    s_waitcnt lgkmcnt(6)
    v_mfma_f32_32x32x16_bf16 v[32:47], v[172:175], v[76:79], v[32:47]
    v_mul_f32 v108, v52, v60
    v_mul_f32 v109, v53, v61
    v_mul_f32 v110, v54, v62
    v_mul_f32 v111, v55, v63
    ds_read_b128 v[72:75], v12 offset:18432
    s_waitcnt lgkmcnt(6)
    v_mfma_f32_32x32x16_bf16 v[32:47], v[176:179], v[80:83], v[32:47]
    v_add_f32 v96, 1.0, v96
    v_add_f32 v97, 1.0, v97
    v_add_f32 v98, 1.0, v98
    v_add_f32 v99, 1.0, v99
    ds_read_b128 v[76:79], v12 offset:19456
    s_waitcnt lgkmcnt(6)
    v_mfma_f32_32x32x16_bf16 v[32:47], v[180:183], v[84:87], v[32:47]
    v_add_f32 v100, 1.0, v100
    v_add_f32 v101, 1.0, v101
    v_add_f32 v102, 1.0, v102
    v_add_f32 v103, 1.0, v103
    ds_read_b128 v[80:83], v12 offset:20480
    s_waitcnt lgkmcnt(6)
    v_mfma_f32_32x32x16_bf16 v[32:47], v[184:187], v[88:91], v[32:47]
    v_rcp_f32 v96, v96
    v_rcp_f32 v97, v97
    v_rcp_f32 v98, v98
    v_rcp_f32 v99, v99
    ds_read_b128 v[84:87], v12 offset:21504
    s_waitcnt lgkmcnt(6)
    v_mfma_f32_32x32x16_bf16 v[32:47], v[188:191], v[92:95], v[32:47]
    v_rcp_f32 v100, v100
    v_rcp_f32 v101, v101
    v_rcp_f32 v102, v102
    v_rcp_f32 v103, v103
    ds_read_b128 v[88:91], v12 offset:22528
    s_waitcnt lgkmcnt(6)
    v_mfma_f32_32x32x16_bf16 v[32:47], v[192:195], v[64:67], v[32:47]
    v_mul_f32 v104, v104, v96
    v_mul_f32 v105, v105, v97
    v_mul_f32 v106, v106, v98
    v_mul_f32 v107, v107, v99
    ds_read_b128 v[92:95], v12 offset:23552
    s_waitcnt lgkmcnt(6)
    v_mfma_f32_32x32x16_bf16 v[32:47], v[196:199], v[68:71], v[32:47]
    v_mul_f32 v108, v108, v100
    v_mul_f32 v109, v109, v101
    v_mul_f32 v110, v110, v102
    v_mul_f32 v111, v111, v103
    ds_read_b128 v[64:67], v12 offset:24576
    s_waitcnt lgkmcnt(6)
    v_mfma_f32_32x32x16_bf16 v[32:47], v[200:203], v[72:75], v[32:47]
    v_cvt_pk_bf16_f32 v116, v104, v105
    v_cvt_pk_bf16_f32 v117, v106, v107
    v_cvt_pk_bf16_f32 v118, v108, v109
    v_cvt_pk_bf16_f32 v119, v110, v111
    ds_read_b128 v[68:71], v12 offset:25600
    s_waitcnt lgkmcnt(6)
    v_mfma_f32_32x32x16_bf16 v[32:47], v[204:207], v[76:79], v[32:47]
    ds_read_b128 v[72:75], v12 offset:26624
    s_waitcnt lgkmcnt(6)
    v_mfma_f32_32x32x16_bf16 v[32:47], v[208:211], v[80:83], v[32:47]
    s_add_u32 s3, s59, 114688
    s_cmp_eq_u32 s53, 1
    s_cbranch_scc1 L_fast_123
    buffer_store_dwordx4 v[116:119], v4, s[44:47], s3 offen sc1
    s_branch L_done_124
L_fast_123:
    buffer_store_dwordx4 v[116:119], v4, s[44:47], s3 offen
L_done_124:
    ds_read_b128 v[76:79], v12 offset:27648
    s_waitcnt lgkmcnt(6)
    v_mfma_f32_32x32x16_bf16 v[32:47], v[212:215], v[84:87], v[32:47]
    ds_read_b128 v[80:83], v12 offset:28672
    s_waitcnt lgkmcnt(6)
    v_mfma_f32_32x32x16_bf16 v[32:47], v[216:219], v[88:91], v[32:47]
    ds_read_b128 v[84:87], v12 offset:29696
    s_waitcnt lgkmcnt(6)
    v_mfma_f32_32x32x16_bf16 v[32:47], v[220:223], v[92:95], v[32:47]
    ds_read_b128 v[88:91], v12 offset:30720
    s_waitcnt lgkmcnt(6)
    v_mfma_f32_32x32x16_bf16 v[32:47], v[224:227], v[64:67], v[32:47]
    ds_read_b128 v[92:95], v12 offset:31744
    s_waitcnt lgkmcnt(6)
    v_mfma_f32_32x32x16_bf16 v[32:47], v[228:231], v[68:71], v[32:47]
    s_waitcnt vmcnt(2)
    s_waitcnt lgkmcnt(0)
    s_barrier
    ds_read_b128 v[64:67], v12 offset:32768
    v_mfma_f32_32x32x16_bf16 v[32:47], v[232:235], v[72:75], v[32:47]
    ds_read_b128 v[68:71], v12 offset:33792
    v_mfma_f32_32x32x16_bf16 v[32:47], v[236:239], v[76:79], v[32:47]
    ds_read_b128 v[72:75], v12 offset:34816
    v_mfma_f32_32x32x16_bf16 v[32:47], v[240:243], v[80:83], v[32:47]
    ds_read_b128 v[76:79], v12 offset:35840
    v_mfma_f32_32x32x16_bf16 v[32:47], v[244:247], v[84:87], v[32:47]
    ds_read_b128 v[80:83], v12 offset:36864
    v_mfma_f32_32x32x16_bf16 v[32:47], v[248:251], v[88:91], v[32:47]
    ds_read_b128 v[84:87], v12 offset:37888
    v_mfma_f32_32x32x16_bf16 v[32:47], v[252:255], v[92:95], v[32:47]
    ds_read_b128 v[88:91], v12 offset:38912
    s_waitcnt lgkmcnt(6)
    v_mfma_f32_32x32x16_bf16 v[48:63], v[128:131], v[64:67], 0
    ds_read_b128 v[92:95], v12 offset:39936
    s_waitcnt lgkmcnt(6)
    v_mfma_f32_32x32x16_bf16 v[48:63], v[132:135], v[68:71], v[48:63]
    ds_read_b128 v[64:67], v12 offset:40960
    s_waitcnt lgkmcnt(6)
    v_mfma_f32_32x32x16_bf16 v[48:63], v[136:139], v[72:75], v[48:63]
    s_nop 2
    v_mul_f32 v96, v32, v32
    v_mul_f32 v97, v33, v33
    v_mul_f32 v98, v34, v34
    v_mul_f32 v99, v35, v35
    ds_read_b128 v[68:71], v12 offset:41984
    s_waitcnt lgkmcnt(6)
    v_mfma_f32_32x32x16_bf16 v[48:63], v[140:143], v[76:79], v[48:63]
    v_mul_f32 v100, v36, v36
    v_mul_f32 v101, v37, v37
    v_mul_f32 v102, v38, v38
    v_mul_f32 v103, v39, v39
    ds_read_b128 v[72:75], v12 offset:43008
    s_waitcnt lgkmcnt(6)
    v_mfma_f32_32x32x16_bf16 v[48:63], v[144:147], v[80:83], v[48:63]
    v_fma_f32 v96, v96, s90, v13
    v_fma_f32 v97, v97, s90, v13
    v_fma_f32 v98, v98, s90, v13
    v_fma_f32 v99, v99, s90, v13
    ds_read_b128 v[76:79], v12 offset:44032
    s_waitcnt lgkmcnt(6)
    v_mfma_f32_32x32x16_bf16 v[48:63], v[148:151], v[84:87], v[48:63]
    v_fma_f32 v100, v100, s90, v13
    v_fma_f32 v101, v101, s90, v13
    v_fma_f32 v102, v102, s90, v13
    v_fma_f32 v103, v103, s90, v13
    ds_read_b128 v[80:83], v12 offset:45056
    s_waitcnt lgkmcnt(6)
    v_mfma_f32_32x32x16_bf16 v[48:63], v[152:155], v[88:91], v[48:63]
    v_mul_f32 v96, v96, v32
    v_mul_f32 v97, v97, v33
    v_mul_f32 v98, v98, v34
    v_mul_f32 v99, v99, v35
    ds_read_b128 v[84:87], v12 offset:46080
    s_waitcnt lgkmcnt(6)
    v_mfma_f32_32x32x16_bf16 v[48:63], v[156:159], v[92:95], v[48:63]
    v_mul_f32 v100, v100, v36
    v_mul_f32 v101, v101, v37
    v_mul_f32 v102, v102, v38
    v_mul_f32 v103, v103, v39
    ds_read_b128 v[88:91], v12 offset:47104
    s_waitcnt lgkmcnt(6)
    v_mfma_f32_32x32x16_bf16 v[48:63], v[160:163], v[64:67], v[48:63]
    v_exp_f32 v96, v96
    v_exp_f32 v97, v97
    v_exp_f32 v98, v98
    v_exp_f32 v99, v99
    s_lshl_b32 s4, s89, 13
    v_add_u32 v127, s4, v127
    v_add_u32 v14, 131072, v127
    v_xor_b32 v15, 64, v14
    ds_read_b64_tr_b16 v[128:129], v14 offset:0
    ds_read_b64_tr_b16 v[130:131], v14 offset:1024
    ds_read_b64_tr_b16 v[132:133], v15 offset:0
    ds_read_b64_tr_b16 v[134:135], v15 offset:1024
    ds_read_b128 v[92:95], v12 offset:48128
    s_waitcnt lgkmcnt(10)
    v_mfma_f32_32x32x16_bf16 v[48:63], v[164:167], v[68:71], v[48:63]
    v_exp_f32 v100, v100
    v_exp_f32 v101, v101
    v_exp_f32 v102, v102
    v_exp_f32 v103, v103
    ds_read_b64_tr_b16 v[136:137], v14 offset:2048
    ds_read_b64_tr_b16 v[138:139], v14 offset:3072
    ds_read_b64_tr_b16 v[140:141], v15 offset:2048
    ds_read_b64_tr_b16 v[142:143], v15 offset:3072
    ds_read_b128 v[64:67], v12 offset:49152
    s_waitcnt lgkmcnt(14)
    v_mfma_f32_32x32x16_bf16 v[48:63], v[168:171], v[72:75], v[48:63]
    v_mul_f32 v104, v32, v40
    v_mul_f32 v105, v33, v41
    v_mul_f32 v106, v34, v42
    v_mul_f32 v107, v35, v43
    ds_read_b64_tr_b16 v[144:145], v14 offset:4096
    ds_read_b64_tr_b16 v[146:147], v14 offset:5120
    ds_read_b64_tr_b16 v[148:149], v15 offset:4096
    ds_read_b64_tr_b16 v[150:151], v15 offset:5120
    ds_read_b128 v[68:71], v12 offset:50176
    s_waitcnt lgkmcnt(15)
    v_mfma_f32_32x32x16_bf16 v[48:63], v[172:175], v[76:79], v[48:63]
    v_mul_f32 v108, v36, v44
    v_mul_f32 v109, v37, v45
    v_mul_f32 v110, v38, v46
    v_mul_f32 v111, v39, v47
    ds_read_b64_tr_b16 v[152:153], v14 offset:6144
    ds_read_b64_tr_b16 v[154:155], v14 offset:7168
    ds_read_b64_tr_b16 v[156:157], v15 offset:6144
    ds_read_b64_tr_b16 v[158:159], v15 offset:7168
    ds_read_b128 v[72:75], v12 offset:51200
    v_mfma_f32_32x32x16_bf16 v[48:63], v[176:179], v[80:83], v[48:63]
    v_add_f32 v96, 1.0, v96
    v_add_f32 v97, 1.0, v97
    v_add_f32 v98, 1.0, v98
    v_add_f32 v99, 1.0, v99
    v_add_u32 v14, 0, v127
    v_xor_b32 v15, 64, v14
    ds_read_b64_tr_b16 v[160:161], v14 offset:0
    ds_read_b64_tr_b16 v[162:163], v14 offset:1024
    ds_read_b64_tr_b16 v[164:165], v15 offset:0
    ds_read_b64_tr_b16 v[166:167], v15 offset:1024
    ds_read_b128 v[76:79], v12 offset:52224
    v_mfma_f32_32x32x16_bf16 v[48:63], v[180:183], v[84:87], v[48:63]
    v_add_f32 v100, 1.0, v100
    v_add_f32 v101, 1.0, v101
    v_add_f32 v102, 1.0, v102
    v_add_f32 v103, 1.0, v103
    ds_read_b64_tr_b16 v[168:169], v14 offset:2048
    ds_read_b64_tr_b16 v[170:171], v14 offset:3072
    ds_read_b64_tr_b16 v[172:173], v15 offset:2048
    ds_read_b64_tr_b16 v[174:175], v15 offset:3072
    ds_read_b128 v[80:83], v12 offset:53248
    v_mfma_f32_32x32x16_bf16 v[48:63], v[184:187], v[88:91], v[48:63]
    v_rcp_f32 v96, v96
    v_rcp_f32 v97, v97
    v_rcp_f32 v98, v98
    v_rcp_f32 v99, v99
    ds_read_b64_tr_b16 v[176:177], v14 offset:4096
    ds_read_b64_tr_b16 v[178:179], v14 offset:5120
    ds_read_b128 v[84:87], v12 offset:54272
    s_waitcnt lgkmcnt(15)
    v_mfma_f32_32x32x16_bf16 v[48:63], v[188:191], v[92:95], v[48:63]
    v_rcp_f32 v100, v100
    v_rcp_f32 v101, v101
    v_rcp_f32 v102, v102
    v_rcp_f32 v103, v103
    ds_read_b64_tr_b16 v[180:181], v15 offset:4096
    ds_read_b64_tr_b16 v[182:183], v15 offset:5120
    ds_read_b128 v[88:91], v12 offset:55296
    v_mfma_f32_32x32x16_bf16 v[48:63], v[192:195], v[64:67], v[48:63]
    v_mul_f32 v104, v104, v96
    v_mul_f32 v105, v105, v97
    v_mul_f32 v106, v106, v98
    v_mul_f32 v107, v107, v99
    ds_read_b64_tr_b16 v[184:185], v14 offset:6144
    ds_read_b64_tr_b16 v[186:187], v14 offset:7168
    ds_read_b128 v[92:95], v12 offset:56320
    v_mfma_f32_32x32x16_bf16 v[48:63], v[196:199], v[68:71], v[48:63]
    v_mul_f32 v108, v108, v100
    v_mul_f32 v109, v109, v101
    v_mul_f32 v110, v110, v102
    v_mul_f32 v111, v111, v103
    ds_read_b64_tr_b16 v[188:189], v15 offset:6144
    ds_read_b64_tr_b16 v[190:191], v15 offset:7168
    ds_read_b128 v[64:67], v12 offset:57344
    s_waitcnt lgkmcnt(15)
    v_mfma_f32_32x32x16_bf16 v[48:63], v[200:203], v[72:75], v[48:63]
    v_cvt_pk_bf16_f32 v112, v104, v105
    v_cvt_pk_bf16_f32 v113, v106, v107
    v_cvt_pk_bf16_f32 v114, v108, v109
    v_cvt_pk_bf16_f32 v115, v110, v111
    ds_read_b128 v[68:71], v12 offset:58368
    v_mfma_f32_32x32x16_bf16 v[48:63], v[204:207], v[76:79], v[48:63]
    s_waitcnt vmcnt(0)
    s_waitcnt lgkmcnt(0)
    s_barrier
    ds_read_b128 v[72:75], v12 offset:59392
    v_mfma_f32_32x32x16_bf16 v[48:63], v[208:211], v[80:83], v[48:63]
    s_add_u32 s3, s59, 229376
    s_cmp_eq_u32 s53, 1
    s_cbranch_scc1 L_fast_125
    buffer_store_dwordx4 v[112:115], v4, s[44:47], s3 offen sc1
    s_branch L_done_126
L_fast_125:
    buffer_store_dwordx4 v[112:115], v4, s[44:47], s3 offen
L_done_126:
    ds_read_b128 v[76:79], v12 offset:60416
    v_mfma_f32_32x32x16_bf16 v[48:63], v[212:215], v[84:87], v[48:63]
    ds_read_b128 v[80:83], v12 offset:61440
    v_mfma_f32_32x32x16_bf16 v[48:63], v[216:219], v[88:91], v[48:63]
    ds_read_b128 v[84:87], v12 offset:62464
    v_mfma_f32_32x32x16_bf16 v[48:63], v[220:223], v[92:95], v[48:63]
    ds_read_b128 v[88:91], v12 offset:63488
    v_mfma_f32_32x32x16_bf16 v[48:63], v[224:227], v[64:67], v[48:63]
    ds_read_b128 v[92:95], v12 offset:64512
    v_mfma_f32_32x32x16_bf16 v[48:63], v[228:231], v[68:71], v[48:63]
    s_waitcnt lgkmcnt(5)
    v_mfma_f32_32x32x16_bf16 v[48:63], v[232:235], v[72:75], v[48:63]
    s_waitcnt lgkmcnt(4)
    v_mfma_f32_32x32x16_bf16 v[48:63], v[236:239], v[76:79], v[48:63]
    s_waitcnt lgkmcnt(3)
    v_mfma_f32_32x32x16_bf16 v[48:63], v[240:243], v[80:83], v[48:63]
    s_waitcnt lgkmcnt(2)
    v_mfma_f32_32x32x16_bf16 v[48:63], v[244:247], v[84:87], v[48:63]
    s_waitcnt lgkmcnt(1)
    v_mfma_f32_32x32x16_bf16 v[48:63], v[248:251], v[88:91], v[48:63]
    s_waitcnt lgkmcnt(0)
    v_mfma_f32_32x32x16_bf16 v[48:63], v[252:255], v[92:95], v[48:63]
    s_add_u32 s5, s100, 20480
    v_and_b32 v2, 15, v1
    v_lshlrev_b32 v2, 3, v2
    buffer_load_dwordx2 v[66:67], v2, s[44:47], s5 offen sc1
    s_and_b32 s6, s88, 7
    s_mul_i32 s6, s6, 114688
    s_lshl_b32 s4, s48, 20
    s_add_u32 s6, s6, s4
    s_mul_i32 s4, s89, 28672
    s_add_u32 s6, s6, s4
    s_add_u32 s6, s6, 1048576
    s_nop 0
    v_mul_f32 v96, v48, v48
    v_mul_f32 v97, v49, v49
    v_mul_f32 v98, v50, v50
    v_mul_f32 v99, v51, v51
    v_mul_f32 v100, v52, v52
    v_mul_f32 v101, v53, v53
    v_mul_f32 v102, v54, v54
    v_mul_f32 v103, v55, v55
    v_fma_f32 v96, v96, s90, v13
    v_fma_f32 v97, v97, s90, v13
    v_fma_f32 v98, v98, s90, v13
    v_fma_f32 v99, v99, s90, v13
    v_fma_f32 v100, v100, s90, v13
    v_fma_f32 v101, v101, s90, v13
    v_fma_f32 v102, v102, s90, v13
    v_fma_f32 v103, v103, s90, v13
    v_mul_f32 v96, v96, v48
    v_mul_f32 v97, v97, v49
    v_mul_f32 v98, v98, v50
    v_mul_f32 v99, v99, v51
    v_mul_f32 v100, v100, v52
    v_mul_f32 v101, v101, v53
    v_mul_f32 v102, v102, v54
    v_mul_f32 v103, v103, v55
    v_exp_f32 v96, v96
    v_exp_f32 v97, v97
    v_exp_f32 v98, v98
    v_exp_f32 v99, v99
    v_exp_f32 v100, v100
    v_exp_f32 v101, v101
    v_exp_f32 v102, v102
    v_exp_f32 v103, v103
    v_mul_f32 v104, v48, v56
    v_mul_f32 v105, v49, v57
    v_mul_f32 v106, v50, v58
    v_mul_f32 v107, v51, v59
    v_mul_f32 v108, v52, v60
    v_mul_f32 v109, v53, v61
    v_mul_f32 v110, v54, v62
    v_mul_f32 v111, v55, v63
    v_add_f32 v96, 1.0, v96
    v_add_f32 v97, 1.0, v97
    v_add_f32 v98, 1.0, v98
    v_add_f32 v99, 1.0, v99
    v_add_f32 v100, 1.0, v100
    v_add_f32 v101, 1.0, v101
    v_add_f32 v102, 1.0, v102
    v_add_f32 v103, 1.0, v103
    v_rcp_f32 v96, v96
    v_rcp_f32 v97, v97
    v_rcp_f32 v98, v98
    v_rcp_f32 v99, v99
    v_rcp_f32 v100, v100
    v_rcp_f32 v101, v101
    v_rcp_f32 v102, v102
    v_rcp_f32 v103, v103
    v_mul_f32 v104, v104, v96
    v_mul_f32 v105, v105, v97
    v_mul_f32 v106, v106, v98
    v_mul_f32 v107, v107, v99
    v_mul_f32 v108, v108, v100
    v_mul_f32 v109, v109, v101
    v_mul_f32 v110, v110, v102
    v_mul_f32 v111, v111, v103
    v_cvt_pk_bf16_f32 v116, v104, v105
    v_cvt_pk_bf16_f32 v117, v106, v107
    v_cvt_pk_bf16_f32 v118, v108, v109
    v_cvt_pk_bf16_f32 v119, v110, v111
    s_add_u32 s3, s59, 344064
    s_cmp_eq_u32 s53, 1
    s_cbranch_scc1 L_fast_127
    buffer_store_dwordx4 v[116:119], v4, s[44:47], s3 offen sc1
    s_branch L_done_128
L_fast_127:
    buffer_store_dwordx4 v[116:119], v4, s[44:47], s3 offen
L_done_128:
    s_cmp_gt_u32 s50, 3
    s_cbranch_scc1 L_lateend_129
    s_waitcnt vmcnt(1)
    s_mov_b32 s7, 400000
L_fw_130:
    v_xor_b32 v66, s51, v66
    v_xor_b32 v67, s52, v67
    v_or_b32 v66, v66, v67
    v_cmp_ne_u32 vcc, 0, v66
    s_nop 0
    s_cmp_eq_u64 vcc, 0
    s_cbranch_scc1 L_fwd_131
    buffer_load_dwordx2 v[66:67], v2, s[44:47], s5 offen sc1
    s_waitcnt vmcnt(0)
    s_sub_u32 s7, s7, 1
    s_cmp_lg_u32 s7, 0
    s_cbranch_scc1 L_fw_130
L_fwd_131:
    buffer_load_dwordx4 v[192:195], v4, s[44:47], s6 offen offset:0 sc1
    buffer_load_dwordx4 v[196:199], v4, s[44:47], s6 offen offset:1024 sc1
    buffer_load_dwordx4 v[200:203], v4, s[44:47], s6 offen offset:2048 sc1
    buffer_load_dwordx4 v[204:207], v4, s[44:47], s6 offen offset:3072 sc1
    s_add_u32 s6, s6, 4096
    buffer_load_dwordx4 v[208:211], v4, s[44:47], s6 offen offset:0 sc1
    buffer_load_dwordx4 v[212:215], v4, s[44:47], s6 offen offset:1024 sc1
    s_waitcnt vmcnt(6)
    s_branch L_gudone_120
L_lateend_129:
    s_waitcnt vmcnt(0)
    s_branch L_gudone_120
L_idle7_119:
    s_waitcnt vmcnt(0)
    s_barrier
    s_add_u32 m0, s92, 32768
    s_add_u32 s3, s91, 32768
    buffer_load_dwordx4 v4, s[44:47], s3 offen offset:0 sc1 lds
    s_add_u32 m0, s92, 32768
    s_add_u32 s3, s91, 32768
    buffer_load_dwordx4 v4, s[44:47], s3 offen offset:1024 sc1 lds
    s_add_u32 m0, s92, 32768
    s_add_u32 s3, s91, 32768
    buffer_load_dwordx4 v4, s[44:47], s3 offen offset:2048 sc1 lds
    s_add_u32 m0, s92, 32768
    s_add_u32 s3, s91, 32768
    buffer_load_dwordx4 v4, s[44:47], s3 offen offset:3072 sc1 lds
    s_add_u32 m0, s92, 65536
    s_add_u32 s3, s91, 65536
    buffer_load_dwordx4 v4, s[44:47], s3 offen offset:0 sc1 lds
    s_add_u32 m0, s92, 65536
    s_add_u32 s3, s91, 65536
    buffer_load_dwordx4 v4, s[44:47], s3 offen offset:1024 sc1 lds
    s_add_u32 m0, s92, 65536
    s_add_u32 s3, s91, 65536
    buffer_load_dwordx4 v4, s[44:47], s3 offen offset:2048 sc1 lds
    s_add_u32 m0, s92, 65536
    s_add_u32 s3, s91, 65536
    buffer_load_dwordx4 v4, s[44:47], s3 offen offset:3072 sc1 lds
    s_add_u32 m0, s92, 98304
    s_add_u32 s3, s91, 98304
    buffer_load_dwordx4 v4, s[44:47], s3 offen offset:0 sc1 lds
    s_add_u32 m0, s92, 98304
    s_add_u32 s3, s91, 98304
    buffer_load_dwordx4 v4, s[44:47], s3 offen offset:1024 sc1 lds
    s_add_u32 m0, s92, 98304
    s_add_u32 s3, s91, 98304
    buffer_load_dwordx4 v4, s[44:47], s3 offen offset:2048 sc1 lds
    s_add_u32 m0, s92, 98304
    s_add_u32 s3, s91, 98304
    buffer_load_dwordx4 v4, s[44:47], s3 offen offset:3072 sc1 lds
    s_waitcnt vmcnt(0)
    s_barrier
    s_mov_b32 s80, 0
    s_mov_b32 s81, 131072
    s_mov_b32 s82, 4
L_wd7_132:
    s_add_u32 m0, s81, 0
    s_add_u32 s83, s80, 0
    buffer_load_dwordx4 v7, s[28:31], s83 offen lds
    s_add_u32 m0, s81, 1024
    s_add_u32 s83, s80, 8192
    buffer_load_dwordx4 v7, s[28:31], s83 offen lds
    s_add_u32 m0, s81, 2048
    s_add_u32 s83, s80, 16384
    buffer_load_dwordx4 v7, s[28:31], s83 offen lds
    s_add_u32 m0, s81, 3072
    s_add_u32 s83, s80, 24576
    buffer_load_dwordx4 v7, s[28:31], s83 offen lds
    s_add_u32 m0, s81, 4096
    s_add_u32 s83, s80, 32768
    buffer_load_dwordx4 v7, s[28:31], s83 offen lds
    s_add_u32 m0, s81, 5120
    s_add_u32 s83, s80, 40960
    buffer_load_dwordx4 v7, s[28:31], s83 offen lds
    s_add_u32 m0, s81, 6144
    s_add_u32 s83, s80, 49152
    buffer_load_dwordx4 v7, s[28:31], s83 offen lds
    s_add_u32 m0, s81, 7168
    s_add_u32 s83, s80, 57344
    buffer_load_dwordx4 v7, s[28:31], s83 offen lds
    s_add_u32 s80, s80, 458752
    s_add_u32 s81, s81, 8192
    s_sub_u32 s82, s82, 1
    s_cmp_lg_u32 s82, 0
    s_cbranch_scc1 L_wd7_132
    s_mov_b32 s80, 65536
    s_mov_b32 s81, 0
    s_mov_b32 s82, 4
L_wd7_133:
    s_add_u32 m0, s81, 0
    s_add_u32 s83, s80, 0
    buffer_load_dwordx4 v7, s[28:31], s83 offen lds
    s_add_u32 m0, s81, 1024
    s_add_u32 s83, s80, 8192
    buffer_load_dwordx4 v7, s[28:31], s83 offen lds
    s_add_u32 m0, s81, 2048
    s_add_u32 s83, s80, 16384
    buffer_load_dwordx4 v7, s[28:31], s83 offen lds
    s_add_u32 m0, s81, 3072
    s_add_u32 s83, s80, 24576
    buffer_load_dwordx4 v7, s[28:31], s83 offen lds
    s_add_u32 m0, s81, 4096
    s_add_u32 s83, s80, 32768
    buffer_load_dwordx4 v7, s[28:31], s83 offen lds
    s_add_u32 m0, s81, 5120
    s_add_u32 s83, s80, 40960
    buffer_load_dwordx4 v7, s[28:31], s83 offen lds
    s_add_u32 m0, s81, 6144
    s_add_u32 s83, s80, 49152
    buffer_load_dwordx4 v7, s[28:31], s83 offen lds
    s_add_u32 m0, s81, 7168
    s_add_u32 s83, s80, 57344
    buffer_load_dwordx4 v7, s[28:31], s83 offen lds
    s_add_u32 s80, s80, 458752
    s_add_u32 s81, s81, 8192
    s_sub_u32 s82, s82, 1
    s_cmp_lg_u32 s82, 0
    s_cbranch_scc1 L_wd7_133
    s_barrier
    s_mov_b32 s80, 131072
    s_mov_b32 s81, 32768
    s_mov_b32 s82, 4
L_wd7_134:
    s_add_u32 m0, s81, 0
    s_add_u32 s83, s80, 0
    buffer_load_dwordx4 v7, s[28:31], s83 offen lds
    s_add_u32 m0, s81, 1024
    s_add_u32 s83, s80, 8192
    buffer_load_dwordx4 v7, s[28:31], s83 offen lds
    s_add_u32 m0, s81, 2048
    s_add_u32 s83, s80, 16384
    buffer_load_dwordx4 v7, s[28:31], s83 offen lds
    s_add_u32 m0, s81, 3072
    s_add_u32 s83, s80, 24576
    buffer_load_dwordx4 v7, s[28:31], s83 offen lds
    s_add_u32 m0, s81, 4096
    s_add_u32 s83, s80, 32768
    buffer_load_dwordx4 v7, s[28:31], s83 offen lds
    s_add_u32 m0, s81, 5120
    s_add_u32 s83, s80, 40960
    buffer_load_dwordx4 v7, s[28:31], s83 offen lds
    s_add_u32 m0, s81, 6144
    s_add_u32 s83, s80, 49152
    buffer_load_dwordx4 v7, s[28:31], s83 offen lds
    s_add_u32 m0, s81, 7168
    s_add_u32 s83, s80, 57344
    buffer_load_dwordx4 v7, s[28:31], s83 offen lds
    s_add_u32 s80, s80, 458752
    s_add_u32 s81, s81, 8192
    s_sub_u32 s82, s82, 1
    s_cmp_lg_u32 s82, 0
    s_cbranch_scc1 L_wd7_134
    s_waitcnt vmcnt(32)
    s_barrier
    s_mov_b32 s80, 196608
    s_mov_b32 s81, 65536
    s_mov_b32 s82, 4
L_wd7_135:
    s_add_u32 m0, s81, 0
    s_add_u32 s83, s80, 0
    buffer_load_dwordx4 v7, s[28:31], s83 offen lds
    s_add_u32 m0, s81, 1024
    s_add_u32 s83, s80, 8192
    buffer_load_dwordx4 v7, s[28:31], s83 offen lds
    s_add_u32 m0, s81, 2048
    s_add_u32 s83, s80, 16384
    buffer_load_dwordx4 v7, s[28:31], s83 offen lds
    s_add_u32 m0, s81, 3072
    s_add_u32 s83, s80, 24576
    buffer_load_dwordx4 v7, s[28:31], s83 offen lds
    s_add_u32 m0, s81, 4096
    s_add_u32 s83, s80, 32768
    buffer_load_dwordx4 v7, s[28:31], s83 offen lds
    s_add_u32 m0, s81, 5120
    s_add_u32 s83, s80, 40960
    buffer_load_dwordx4 v7, s[28:31], s83 offen lds
    s_add_u32 m0, s81, 6144
    s_add_u32 s83, s80, 49152
    buffer_load_dwordx4 v7, s[28:31], s83 offen lds
    s_add_u32 m0, s81, 7168
    s_add_u32 s83, s80, 57344
    buffer_load_dwordx4 v7, s[28:31], s83 offen lds
    s_add_u32 s80, s80, 458752
    s_add_u32 s81, s81, 8192
    s_sub_u32 s82, s82, 1
    s_cmp_lg_u32 s82, 0
    s_cbranch_scc1 L_wd7_135
    s_lshl_b32 s4, s89, 13
    v_add_u32 v127, s4, v127
    v_add_u32 v14, 131072, v127
    v_xor_b32 v15, 64, v14
    ds_read_b64_tr_b16 v[128:129], v14 offset:0
    ds_read_b64_tr_b16 v[130:131], v14 offset:1024
    ds_read_b64_tr_b16 v[132:133], v15 offset:0
    ds_read_b64_tr_b16 v[134:135], v15 offset:1024
    ds_read_b64_tr_b16 v[136:137], v14 offset:2048
    ds_read_b64_tr_b16 v[138:139], v14 offset:3072
    ds_read_b64_tr_b16 v[140:141], v15 offset:2048
    ds_read_b64_tr_b16 v[142:143], v15 offset:3072
    ds_read_b64_tr_b16 v[144:145], v14 offset:4096
    ds_read_b64_tr_b16 v[146:147], v14 offset:5120
    ds_read_b64_tr_b16 v[148:149], v15 offset:4096
    ds_read_b64_tr_b16 v[150:151], v15 offset:5120
    ds_read_b64_tr_b16 v[152:153], v14 offset:6144
    ds_read_b64_tr_b16 v[154:155], v14 offset:7168
    ds_read_b64_tr_b16 v[156:157], v15 offset:6144
    ds_read_b64_tr_b16 v[158:159], v15 offset:7168
    v_add_u32 v14, 0, v127
    v_xor_b32 v15, 64, v14
    ds_read_b64_tr_b16 v[160:161], v14 offset:0
    ds_read_b64_tr_b16 v[162:163], v14 offset:1024
    ds_read_b64_tr_b16 v[164:165], v15 offset:0
    ds_read_b64_tr_b16 v[166:167], v15 offset:1024
    ds_read_b64_tr_b16 v[168:169], v14 offset:2048
    ds_read_b64_tr_b16 v[170:171], v14 offset:3072
    ds_read_b64_tr_b16 v[172:173], v15 offset:2048
    ds_read_b64_tr_b16 v[174:175], v15 offset:3072
    ds_read_b64_tr_b16 v[176:177], v14 offset:4096
    ds_read_b64_tr_b16 v[178:179], v14 offset:5120
    ds_read_b64_tr_b16 v[180:181], v15 offset:4096
    ds_read_b64_tr_b16 v[182:183], v15 offset:5120
    ds_read_b64_tr_b16 v[184:185], v14 offset:6144
    ds_read_b64_tr_b16 v[186:187], v14 offset:7168
    ds_read_b64_tr_b16 v[188:189], v15 offset:6144
    ds_read_b64_tr_b16 v[190:191], v15 offset:7168
    s_waitcnt vmcnt(0) lgkmcnt(0)
    s_barrier
    s_lshl_b32 s3, s58, 3
    s_add_u32 s3, s3, s100
    s_add_u32 s3, s3, 20480
    v_mov_b32 v64, s51
    v_mov_b32 v65, s52
    v_mov_b32 v2, 0
    s_mov_b64 exec, 1
    s_cmp_eq_u32 s53, 1
    s_cbranch_scc1 L_fast_136
    buffer_store_dwordx2 v[64:65], v2, s[44:47], s3 offen sc1
    s_branch L_done_137
L_fast_136:
    buffer_store_dwordx2 v[64:65], v2, s[44:47], s3 offen
L_done_137:
    s_mov_b64 exec, -1
    s_and_b32 s6, s88, 7
    s_mul_i32 s6, s6, 114688
    s_lshl_b32 s4, s48, 20
    s_add_u32 s6, s6, s4
    s_mul_i32 s4, s89, 28672
    s_add_u32 s6, s6, s4
    s_add_u32 s6, s6, 1048576
    s_mov_b32 s80, 262144
    s_mov_b32 s81, 131072
    s_mov_b32 s82, 4
L_wd7_138:
    s_add_u32 m0, s81, 0
    s_add_u32 s83, s80, 0
    buffer_load_dwordx4 v7, s[28:31], s83 offen lds
    s_add_u32 m0, s81, 1024
    s_add_u32 s83, s80, 8192
    buffer_load_dwordx4 v7, s[28:31], s83 offen lds
    s_add_u32 m0, s81, 2048
    s_add_u32 s83, s80, 16384
    buffer_load_dwordx4 v7, s[28:31], s83 offen lds
    s_add_u32 m0, s81, 3072
    s_add_u32 s83, s80, 24576
    buffer_load_dwordx4 v7, s[28:31], s83 offen lds
    s_add_u32 m0, s81, 4096
    s_add_u32 s83, s80, 32768
    buffer_load_dwordx4 v7, s[28:31], s83 offen lds
    s_add_u32 m0, s81, 5120
    s_add_u32 s83, s80, 40960
    buffer_load_dwordx4 v7, s[28:31], s83 offen lds
    s_add_u32 m0, s81, 6144
    s_add_u32 s83, s80, 49152
    buffer_load_dwordx4 v7, s[28:31], s83 offen lds
    s_add_u32 m0, s81, 7168
    s_add_u32 s83, s80, 57344
    buffer_load_dwordx4 v7, s[28:31], s83 offen lds
    s_add_u32 s80, s80, 458752
    s_add_u32 s81, s81, 8192
    s_sub_u32 s82, s82, 1
    s_cmp_lg_u32 s82, 0
    s_cbranch_scc1 L_wd7_138
    s_mov_b32 s80, 327680
    s_mov_b32 s81, 0
    s_mov_b32 s82, 4
L_wd7_139:
    s_add_u32 m0, s81, 0
    s_add_u32 s83, s80, 0
    buffer_load_dwordx4 v7, s[28:31], s83 offen lds
    s_add_u32 m0, s81, 1024
    s_add_u32 s83, s80, 8192
    buffer_load_dwordx4 v7, s[28:31], s83 offen lds
    s_add_u32 m0, s81, 2048
    s_add_u32 s83, s80, 16384
    buffer_load_dwordx4 v7, s[28:31], s83 offen lds
    s_add_u32 m0, s81, 3072
    s_add_u32 s83, s80, 24576
    buffer_load_dwordx4 v7, s[28:31], s83 offen lds
    s_add_u32 m0, s81, 4096
    s_add_u32 s83, s80, 32768
    buffer_load_dwordx4 v7, s[28:31], s83 offen lds
    s_add_u32 m0, s81, 5120
    s_add_u32 s83, s80, 40960
    buffer_load_dwordx4 v7, s[28:31], s83 offen lds
    s_add_u32 m0, s81, 6144
    s_add_u32 s83, s80, 49152
    buffer_load_dwordx4 v7, s[28:31], s83 offen lds
    s_add_u32 m0, s81, 7168
    s_add_u32 s83, s80, 57344
    buffer_load_dwordx4 v7, s[28:31], s83 offen lds
    s_add_u32 s80, s80, 458752
    s_add_u32 s81, s81, 8192
    s_sub_u32 s82, s82, 1
    s_cmp_lg_u32 s82, 0
    s_cbranch_scc1 L_wd7_139
L_gudone_120:
    s_waitcnt lgkmcnt(0)
    s_barrier
    s_mul_i32 s59, s89, 458752
    s_lshr_b32 s3, s50, 2
    s_lshl_b32 s4, s3, 15
    s_add_u32 s59, s59, s4
    s_lshl_b32 s80, s89, 13
    s_lshl_b32 s3, s3, 12
    s_add_u32 s80, s80, s3
    s_cmp_lg_u32 s50, 4
    s_cbranch_scc1 L_n0_141
    s_lshl_b32 s3, s58, 3
    s_add_u32 s3, s3, s100
    s_add_u32 s3, s3, 22528
    v_mov_b32 v64, s51
    v_mov_b32 v65, s52
    v_mov_b32 v2, 0
    s_mov_b64 exec, 1
    s_cmp_eq_u32 s53, 1
    s_cbranch_scc1 L_fast_142
    buffer_store_dwordx2 v[64:65], v2, s[44:47], s3 offen sc1
    s_branch L_done_143
L_fast_142:
    buffer_store_dwordx2 v[64:65], v2, s[44:47], s3 offen
L_done_143:
    s_mov_b64 exec, -1
L_n0_141:
    s_cmp_lt_u32 s50, 4
    s_cbranch_scc1 L_join_140
    s_setprio 3
    s_add_u32 s3, s100, 22528
    v_and_b32 v2, 15, v1
    v_lshlrev_b32 v2, 3, v2
    s_mov_b32 s7, 400000
L_fw_144:
    buffer_load_dwordx2 v[66:67], v2, s[44:47], s3 offen sc1
    s_waitcnt vmcnt(0)
    v_cmp_ne_u32 vcc, s51, v66
    v_cmp_ne_u32 s[4:5], s52, v67
    s_nop 0
    s_or_b64 vcc, vcc, s[4:5]
    s_cbranch_scc0 L_fwd_145
    s_sub_u32 s7, s7, 1
    s_cmp_lg_u32 s7, 0
    s_cbranch_scc1 L_fw_144
L_fwd_145:
    s_setprio 1
    buffer_load_dwordx4 v[192:195], v4, s[44:47], s6 offen offset:0 sc1
    buffer_load_dwordx4 v[196:199], v4, s[44:47], s6 offen offset:1024 sc1
    buffer_load_dwordx4 v[200:203], v4, s[44:47], s6 offen offset:2048 sc1
    buffer_load_dwordx4 v[204:207], v4, s[44:47], s6 offen offset:3072 sc1
    s_add_u32 s6, s6, 4096
    buffer_load_dwordx4 v[208:211], v4, s[44:47], s6 offen offset:0 sc1
    buffer_load_dwordx4 v[212:215], v4, s[44:47], s6 offen offset:1024 sc1
L_join_140:
    s_waitcnt vmcnt(5)
    v_mfma_f32_32x32x16_bf16 v[32:47], v[128:131], v[192:195], 0
    v_mfma_f32_32x32x16_bf16 v[48:63], v[132:135], v[192:195], 0
    buffer_load_dwordx4 v[216:219], v4, s[44:47], s6 offen offset:2048 sc1
    s_add_u32 m0, s80, 98304
    s_add_u32 s3, s59, 393216
    buffer_load_dwordx4 v7, s[28:31], s3 offen lds
    s_waitcnt vmcnt(6)
    v_mfma_f32_32x32x16_bf16 v[32:47], v[136:139], v[196:199], v[32:47]
    v_mfma_f32_32x32x16_bf16 v[48:63], v[140:143], v[196:199], v[48:63]
    buffer_load_dwordx4 v[220:223], v4, s[44:47], s6 offen offset:3072 sc1
    s_add_u32 m0, s80, 99328
    s_add_u32 s3, s59, 401408
    buffer_load_dwordx4 v7, s[28:31], s3 offen lds
    s_waitcnt vmcnt(7)
    v_mfma_f32_32x32x16_bf16 v[32:47], v[144:147], v[200:203], v[32:47]
    v_mfma_f32_32x32x16_bf16 v[48:63], v[148:151], v[200:203], v[48:63]
    s_add_u32 s6, s6, 4096
    buffer_load_dwordx4 v[224:227], v4, s[44:47], s6 offen offset:0 sc1
    s_add_u32 m0, s80, 100352
    s_add_u32 s3, s59, 409600
    buffer_load_dwordx4 v7, s[28:31], s3 offen lds
    s_waitcnt vmcnt(8)
    v_mfma_f32_32x32x16_bf16 v[32:47], v[152:155], v[204:207], v[32:47]
    v_mfma_f32_32x32x16_bf16 v[48:63], v[156:159], v[204:207], v[48:63]
    buffer_load_dwordx4 v[228:231], v4, s[44:47], s6 offen offset:1024 sc1
    s_add_u32 m0, s80, 101376
    s_add_u32 s3, s59, 417792
    buffer_load_dwordx4 v7, s[28:31], s3 offen lds
    s_waitcnt vmcnt(9)
    v_mfma_f32_32x32x16_bf16 v[32:47], v[160:163], v[208:211], v[32:47]
    v_mfma_f32_32x32x16_bf16 v[48:63], v[164:167], v[208:211], v[48:63]
    buffer_load_dwordx4 v[232:235], v4, s[44:47], s6 offen offset:2048 sc1
    v_add_u32 v14, 32768, v127
    v_xor_b32 v15, 64, v14
    ds_read_b64_tr_b16 v[64:65], v14 offset:0
    ds_read_b64_tr_b16 v[66:67], v14 offset:1024
    ds_read_b64_tr_b16 v[68:69], v15 offset:0
    ds_read_b64_tr_b16 v[70:71], v15 offset:1024
    s_waitcnt vmcnt(9)
    v_mfma_f32_32x32x16_bf16 v[32:47], v[168:171], v[212:215], v[32:47]
    v_mfma_f32_32x32x16_bf16 v[48:63], v[172:175], v[212:215], v[48:63]
    buffer_load_dwordx4 v[236:239], v4, s[44:47], s6 offen offset:3072 sc1
    ds_read_b64_tr_b16 v[72:73], v14 offset:2048
    ds_read_b64_tr_b16 v[74:75], v14 offset:3072
    ds_read_b64_tr_b16 v[76:77], v15 offset:2048
    ds_read_b64_tr_b16 v[78:79], v15 offset:3072
    s_waitcnt vmcnt(9)
    v_mfma_f32_32x32x16_bf16 v[32:47], v[176:179], v[216:219], v[32:47]
    v_mfma_f32_32x32x16_bf16 v[48:63], v[180:183], v[216:219], v[48:63]
    s_add_u32 s6, s6, 4096
    buffer_load_dwordx4 v[240:243], v4, s[44:47], s6 offen offset:0 sc1
    ds_read_b64_tr_b16 v[80:81], v14 offset:4096
    ds_read_b64_tr_b16 v[82:83], v14 offset:5120
    ds_read_b64_tr_b16 v[84:85], v15 offset:4096
    ds_read_b64_tr_b16 v[86:87], v15 offset:5120
    s_waitcnt vmcnt(8)
    v_mfma_f32_32x32x16_bf16 v[32:47], v[184:187], v[220:223], v[32:47]
    v_mfma_f32_32x32x16_bf16 v[48:63], v[188:191], v[220:223], v[48:63]
    buffer_load_dwordx4 v[244:247], v4, s[44:47], s6 offen offset:1024 sc1
    ds_read_b64_tr_b16 v[88:89], v14 offset:6144
    ds_read_b64_tr_b16 v[90:91], v14 offset:7168
    ds_read_b64_tr_b16 v[92:93], v15 offset:6144
    ds_read_b64_tr_b16 v[94:95], v15 offset:7168
    s_waitcnt vmcnt(7) lgkmcnt(12)
    v_mfma_f32_32x32x16_bf16 v[32:47], v[64:67], v[224:227], v[32:47]
    v_mfma_f32_32x32x16_bf16 v[48:63], v[68:71], v[224:227], v[48:63]
    buffer_load_dwordx4 v[248:251], v4, s[44:47], s6 offen offset:2048 sc1
    v_add_u32 v14, 65536, v127
    v_xor_b32 v15, 64, v14
    ds_read_b64_tr_b16 v[64:65], v14 offset:0
    ds_read_b64_tr_b16 v[66:67], v14 offset:1024
    ds_read_b64_tr_b16 v[68:69], v15 offset:0
    ds_read_b64_tr_b16 v[70:71], v15 offset:1024
    s_waitcnt vmcnt(6) lgkmcnt(12)
    v_mfma_f32_32x32x16_bf16 v[32:47], v[72:75], v[228:231], v[32:47]
    v_mfma_f32_32x32x16_bf16 v[48:63], v[76:79], v[228:231], v[48:63]
    buffer_load_dwordx4 v[252:255], v4, s[44:47], s6 offen offset:3072 sc1
    ds_read_b64_tr_b16 v[72:73], v14 offset:2048
    ds_read_b64_tr_b16 v[74:75], v14 offset:3072
    ds_read_b64_tr_b16 v[76:77], v15 offset:2048
    ds_read_b64_tr_b16 v[78:79], v15 offset:3072
    s_waitcnt vmcnt(5) lgkmcnt(12)
    v_mfma_f32_32x32x16_bf16 v[32:47], v[80:83], v[232:235], v[32:47]
    v_mfma_f32_32x32x16_bf16 v[48:63], v[84:87], v[232:235], v[48:63]
    s_add_u32 s6, s6, 4096
    buffer_load_dwordx4 v[192:195], v4, s[44:47], s6 offen offset:0 sc1
    ds_read_b64_tr_b16 v[80:81], v14 offset:4096
    ds_read_b64_tr_b16 v[82:83], v14 offset:5120
    ds_read_b64_tr_b16 v[84:85], v15 offset:4096
    ds_read_b64_tr_b16 v[86:87], v15 offset:5120
    s_waitcnt vmcnt(5) lgkmcnt(12)
    v_mfma_f32_32x32x16_bf16 v[32:47], v[88:91], v[236:239], v[32:47]
    v_mfma_f32_32x32x16_bf16 v[48:63], v[92:95], v[236:239], v[48:63]
    buffer_load_dwordx4 v[196:199], v4, s[44:47], s6 offen offset:1024 sc1
    ds_read_b64_tr_b16 v[88:89], v14 offset:6144
    ds_read_b64_tr_b16 v[90:91], v14 offset:7168
    ds_read_b64_tr_b16 v[92:93], v15 offset:6144
    ds_read_b64_tr_b16 v[94:95], v15 offset:7168
    s_waitcnt vmcnt(5) lgkmcnt(12)
    v_mfma_f32_32x32x16_bf16 v[32:47], v[64:67], v[240:243], v[32:47]
    v_mfma_f32_32x32x16_bf16 v[48:63], v[68:71], v[240:243], v[48:63]
    buffer_load_dwordx4 v[200:203], v4, s[44:47], s6 offen offset:2048 sc1
    s_waitcnt lgkmcnt(0)
    s_barrier
    v_add_u32 v14, 131072, v127
    v_xor_b32 v15, 64, v14
    ds_read_b64_tr_b16 v[64:65], v14 offset:0
    ds_read_b64_tr_b16 v[66:67], v14 offset:1024
    ds_read_b64_tr_b16 v[68:69], v15 offset:0
    ds_read_b64_tr_b16 v[70:71], v15 offset:1024
    s_waitcnt vmcnt(5)
    v_mfma_f32_32x32x16_bf16 v[32:47], v[72:75], v[244:247], v[32:47]
    v_mfma_f32_32x32x16_bf16 v[48:63], v[76:79], v[244:247], v[48:63]
    buffer_load_dwordx4 v[204:207], v4, s[44:47], s6 offen offset:3072 sc1
    ds_read_b64_tr_b16 v[72:73], v14 offset:2048
    ds_read_b64_tr_b16 v[74:75], v14 offset:3072
    ds_read_b64_tr_b16 v[76:77], v15 offset:2048
    ds_read_b64_tr_b16 v[78:79], v15 offset:3072
    s_waitcnt vmcnt(5)
    v_mfma_f32_32x32x16_bf16 v[32:47], v[80:83], v[248:251], v[32:47]
    v_mfma_f32_32x32x16_bf16 v[48:63], v[84:87], v[248:251], v[48:63]
    s_add_u32 s6, s6, 4096
    buffer_load_dwordx4 v[208:211], v4, s[44:47], s6 offen offset:0 sc1
    ds_read_b64_tr_b16 v[80:81], v14 offset:4096
    ds_read_b64_tr_b16 v[82:83], v14 offset:5120
    ds_read_b64_tr_b16 v[84:85], v15 offset:4096
    ds_read_b64_tr_b16 v[86:87], v15 offset:5120
    s_waitcnt vmcnt(5)
    v_mfma_f32_32x32x16_bf16 v[32:47], v[88:91], v[252:255], v[32:47]
    v_mfma_f32_32x32x16_bf16 v[48:63], v[92:95], v[252:255], v[48:63]
    buffer_load_dwordx4 v[212:215], v4, s[44:47], s6 offen offset:1024 sc1
    ds_read_b64_tr_b16 v[88:89], v14 offset:6144
    ds_read_b64_tr_b16 v[90:91], v14 offset:7168
    ds_read_b64_tr_b16 v[92:93], v15 offset:6144
    ds_read_b64_tr_b16 v[94:95], v15 offset:7168
    s_waitcnt vmcnt(5) lgkmcnt(12)
    v_mfma_f32_32x32x16_bf16 v[32:47], v[64:67], v[192:195], v[32:47]
    v_mfma_f32_32x32x16_bf16 v[48:63], v[68:71], v[192:195], v[48:63]
    buffer_load_dwordx4 v[216:219], v4, s[44:47], s6 offen offset:2048 sc1
    v_add_u32 v14, 0, v127
    v_xor_b32 v15, 64, v14
    ds_read_b64_tr_b16 v[64:65], v14 offset:0
    ds_read_b64_tr_b16 v[66:67], v14 offset:1024
    ds_read_b64_tr_b16 v[68:69], v15 offset:0
    ds_read_b64_tr_b16 v[70:71], v15 offset:1024
    s_waitcnt vmcnt(5) lgkmcnt(12)
    v_mfma_f32_32x32x16_bf16 v[32:47], v[72:75], v[196:199], v[32:47]
    v_mfma_f32_32x32x16_bf16 v[48:63], v[76:79], v[196:199], v[48:63]
    buffer_load_dwordx4 v[220:223], v4, s[44:47], s6 offen offset:3072 sc1
    ds_read_b64_tr_b16 v[72:73], v14 offset:2048
    ds_read_b64_tr_b16 v[74:75], v14 offset:3072
    ds_read_b64_tr_b16 v[76:77], v15 offset:2048
    ds_read_b64_tr_b16 v[78:79], v15 offset:3072
    s_waitcnt vmcnt(5) lgkmcnt(12)
    v_mfma_f32_32x32x16_bf16 v[32:47], v[80:83], v[200:203], v[32:47]
    v_mfma_f32_32x32x16_bf16 v[48:63], v[84:87], v[200:203], v[48:63]
    s_add_u32 s6, s6, 4096
    buffer_load_dwordx4 v[224:227], v4, s[44:47], s6 offen offset:0 sc1
    ds_read_b64_tr_b16 v[80:81], v14 offset:4096
    ds_read_b64_tr_b16 v[82:83], v14 offset:5120
    ds_read_b64_tr_b16 v[84:85], v15 offset:4096
    ds_read_b64_tr_b16 v[86:87], v15 offset:5120
    s_waitcnt vmcnt(5) lgkmcnt(12)
    v_mfma_f32_32x32x16_bf16 v[32:47], v[88:91], v[204:207], v[32:47]
    v_mfma_f32_32x32x16_bf16 v[48:63], v[92:95], v[204:207], v[48:63]
    buffer_load_dwordx4 v[228:231], v4, s[44:47], s6 offen offset:1024 sc1
    ds_read_b64_tr_b16 v[88:89], v14 offset:6144
    ds_read_b64_tr_b16 v[90:91], v14 offset:7168
    ds_read_b64_tr_b16 v[92:93], v15 offset:6144
    ds_read_b64_tr_b16 v[94:95], v15 offset:7168
    s_waitcnt vmcnt(5) lgkmcnt(12)
    v_mfma_f32_32x32x16_bf16 v[32:47], v[64:67], v[208:211], v[32:47]
    v_mfma_f32_32x32x16_bf16 v[48:63], v[68:71], v[208:211], v[48:63]
    buffer_load_dwordx4 v[232:235], v4, s[44:47], s6 offen offset:2048 sc1
    v_add_u32 v14, 98304, v127
    v_xor_b32 v15, 64, v14
    ds_read_b64_tr_b16 v[64:65], v14 offset:0
    ds_read_b64_tr_b16 v[66:67], v14 offset:1024
    ds_read_b64_tr_b16 v[68:69], v15 offset:0
    ds_read_b64_tr_b16 v[70:71], v15 offset:1024
    s_waitcnt vmcnt(5) lgkmcnt(12)
    v_mfma_f32_32x32x16_bf16 v[32:47], v[72:75], v[212:215], v[32:47]
    v_mfma_f32_32x32x16_bf16 v[48:63], v[76:79], v[212:215], v[48:63]
    buffer_load_dwordx4 v[236:239], v4, s[44:47], s6 offen offset:3072 sc1
    ds_read_b64_tr_b16 v[72:73], v14 offset:2048
    ds_read_b64_tr_b16 v[74:75], v14 offset:3072
    ds_read_b64_tr_b16 v[76:77], v15 offset:2048
    ds_read_b64_tr_b16 v[78:79], v15 offset:3072
    s_waitcnt vmcnt(5) lgkmcnt(12)
    v_mfma_f32_32x32x16_bf16 v[32:47], v[80:83], v[216:219], v[32:47]
    v_mfma_f32_32x32x16_bf16 v[48:63], v[84:87], v[216:219], v[48:63]
    ds_read_b64_tr_b16 v[80:81], v14 offset:4096
    ds_read_b64_tr_b16 v[82:83], v14 offset:5120
    ds_read_b64_tr_b16 v[84:85], v15 offset:4096
    ds_read_b64_tr_b16 v[86:87], v15 offset:5120
    s_waitcnt vmcnt(4) lgkmcnt(12)
    v_mfma_f32_32x32x16_bf16 v[32:47], v[88:91], v[220:223], v[32:47]
    v_mfma_f32_32x32x16_bf16 v[48:63], v[92:95], v[220:223], v[48:63]
    ds_read_b64_tr_b16 v[88:89], v14 offset:6144
    ds_read_b64_tr_b16 v[90:91], v14 offset:7168
    ds_read_b64_tr_b16 v[92:93], v15 offset:6144
    ds_read_b64_tr_b16 v[94:95], v15 offset:7168
    s_waitcnt vmcnt(3) lgkmcnt(12)
    v_mfma_f32_32x32x16_bf16 v[32:47], v[64:67], v[224:227], v[32:47]
    v_mfma_f32_32x32x16_bf16 v[48:63], v[68:71], v[224:227], v[48:63]
    s_waitcnt vmcnt(2) lgkmcnt(8)
    v_mfma_f32_32x32x16_bf16 v[32:47], v[72:75], v[228:231], v[32:47]
    v_mfma_f32_32x32x16_bf16 v[48:63], v[76:79], v[228:231], v[48:63]
    s_waitcnt vmcnt(1) lgkmcnt(4)
    v_mfma_f32_32x32x16_bf16 v[32:47], v[80:83], v[232:235], v[32:47]
    v_mfma_f32_32x32x16_bf16 v[48:63], v[84:87], v[232:235], v[48:63]
    s_waitcnt vmcnt(0) lgkmcnt(0)
    v_mfma_f32_32x32x16_bf16 v[32:47], v[88:91], v[236:239], v[32:47]
    v_mfma_f32_32x32x16_bf16 v[48:63], v[92:95], v[236:239], v[48:63]
    s_setprio 0
    v_add_u32 v2, 32768, v125
    s_nop 8
    ds_write_b128 v2, v[32:35]
    v_xor_b32 v97, 16, v2
    ds_write_b128 v97, v[36:39]
    v_xor_b32 v98, 32, v2
    ds_write_b128 v98, v[40:43]
    v_xor_b32 v99, 48, v2
    ds_write_b128 v99, v[44:47]
    v_xor_b32 v100, 64, v2
    ds_write_b128 v100, v[48:51]
    v_xor_b32 v101, 80, v2
    ds_write_b128 v101, v[52:55]
    v_xor_b32 v102, 96, v2
    ds_write_b128 v102, v[56:59]
    v_xor_b32 v103, 112, v2
    ds_write_b128 v103, v[60:63]
    v_lshlrev_b32 v16, 16, v8
    v_and_b32 v17, 0xffff0000, v8
    v_lshlrev_b32 v18, 16, v9
    v_and_b32 v19, 0xffff0000, v9
    v_lshlrev_b32 v20, 16, v10
    v_and_b32 v21, 0xffff0000, v10
    v_lshlrev_b32 v22, 16, v11
    v_and_b32 v23, 0xffff0000, v11
    v_lshlrev_b32 v72, 16, v120
    v_and_b32 v73, 0xffff0000, v120
    v_lshlrev_b32 v74, 16, v121
    v_and_b32 v75, 0xffff0000, v121
    v_lshlrev_b32 v76, 16, v122
    v_and_b32 v77, 0xffff0000, v122
    v_lshlrev_b32 v78, 16, v123
    v_and_b32 v79, 0xffff0000, v123
    v_add_u32 v2, 32768, v126
    v_xor_b32 v3, 128, v2
    s_waitcnt lgkmcnt(0)
    s_barrier
    ds_read_b128 v[32:35], v2 offset:0
    ds_read_b128 v[36:39], v3 offset:0
    ds_read_b128 v[40:43], v2 offset:16384
    ds_read_b128 v[44:47], v3 offset:16384
    ds_read_b128 v[48:51], v2 offset:32768
    ds_read_b128 v[52:55], v3 offset:32768
    ds_read_b128 v[56:59], v2 offset:49152
    ds_read_b128 v[60:63], v3 offset:49152
    s_waitcnt lgkmcnt(4)
    v_pk_add_f32 v[64:65], v[32:33], v[40:41]
    v_pk_add_f32 v[66:67], v[34:35], v[42:43]
    v_pk_add_f32 v[68:69], v[36:37], v[44:45]
    v_pk_add_f32 v[70:71], v[38:39], v[46:47]
    s_waitcnt lgkmcnt(0)
    v_pk_add_f32 v[48:49], v[48:49], v[56:57]
    v_pk_add_f32 v[50:51], v[50:51], v[58:59]
    v_pk_add_f32 v[52:53], v[52:53], v[60:61]
    v_pk_add_f32 v[54:55], v[54:55], v[62:63]
    v_pk_add_f32 v[64:65], v[64:65], v[48:49]
    v_pk_add_f32 v[66:67], v[66:67], v[50:51]
    v_pk_add_f32 v[68:69], v[68:69], v[52:53]
    v_pk_add_f32 v[70:71], v[70:71], v[54:55]
    v_pk_fma_f32 v[72:73], v[64:65], v[16:17], v[72:73]
    v_pk_fma_f32 v[74:75], v[66:67], v[18:19], v[74:75]
    v_pk_fma_f32 v[76:77], v[68:69], v[20:21], v[76:77]
    v_pk_fma_f32 v[78:79], v[70:71], v[22:23], v[78:79]
    v_cvt_pk_bf16_f32 v64, v72, v73
    v_cvt_pk_bf16_f32 v65, v74, v75
    v_cvt_pk_bf16_f32 v66, v76, v77
    v_cvt_pk_bf16_f32 v67, v78, v79
    buffer_store_dwordx4 v[64:67], v124, s[40:43], s98 offen
    s_waitcnt vmcnt(0)
    s_endpgm
L_exit:
    s_endpgm
L_codeend:
.section .rodata,"a"
.p2align 6
.amdhsa_kernel adaLN_cond__softmax_full_mha__glu_gated_geglu__prompt_kernel
  .amdhsa_next_free_vgpr 256
  .amdhsa_next_free_sgpr 102
  .amdhsa_accum_offset 256
  .amdhsa_group_segment_fixed_size 0
  .amdhsa_kernarg_size 96
  .amdhsa_user_sgpr_count 2
  .amdhsa_user_sgpr_kernarg_segment_ptr 1
  .amdhsa_system_sgpr_workgroup_id_x 1
  .amdhsa_float_denorm_mode_32 3
.end_amdhsa_kernel
```
